```python
import torch

def _softmax(x, axis=-1):
    return torch.softmax(x, dim=axis)
def _gelu(x):
    return torch.nn.functional.gelu(x, approximate="tanh")
def _silu(x):
    return torch.nn.functional.silu(x)
def _sigmoid(x):
    return torch.sigmoid(x)
def _layernorm(x, axis=-1, eps=1e-5):
    m = x.mean(dim=axis, keepdim=True)
    v = x.var(dim=axis, keepdim=True, unbiased=False)
    return (x - m) / torch.sqrt(v + eps)
def _scatter_add(tgt, idx, src, axis=0):
    return tgt.clone().index_add_(axis, idx, src)
def _segment_sum(src, seg, n):
    out = torch.zeros((n,) + src.shape[1:], dtype=src.dtype)
    return out.index_add_(0, seg, src)
def _pad(x, pw):
    flat = tuple(v for pair in reversed(pw) for v in pair)
    return torch.nn.functional.pad(x, flat)

kernel_name = 'standalone__gqa_softmax__near_ridge'

def setup_inputs():

    _w = (lambda a: (lambda t: t.to(torch.bfloat16) if t.is_floating_point() else t)(torch.as_tensor(a)))
    B, Hq, Hkv, Sq, Sk, D = 8, 32, 32, 384, 1024, 192
    return {
        "q": _w((lambda *s: torch.randn(*s, dtype=torch.bfloat16) * 0.8)(B, Hq, Sq, D)),
        "k": _w((lambda *s: torch.randn(*s, dtype=torch.bfloat16) * 0.8)(B, Hkv, Sk, D)),
        "v": _w((lambda *s: torch.randn(*s, dtype=torch.bfloat16) * 0.05)(B, Hkv, Sk, D)),
    }

def reference(q, k, v):
    B, Hq, Sq, D = q.shape
    Hkv = k.shape[1]
    rep = Hq // Hkv
    k = (lambda x, n, axis: torch.repeat_interleave(x, n, dim=axis))(k, rep, axis=1)
    v = (lambda x, n, axis: torch.repeat_interleave(x, n, dim=axis))(v, rep, axis=1)
    scale = D ** -0.5
    scores = torch.einsum("bhqd,bhkd->bhqk", q, k) * scale
    p = _softmax(scores, axis=-1)
    return torch.einsum("bhqk,bhkd->bhqd", p, v)
```

```asm
; @launch grid=(256,1,1) block=(256,1,1) lds=163168
.amdgcn_target "amdgcn-amd-amdhsa--gfx950"
.text
.globl standalone__gqa_softmax__near_ridge_kernel
.p2align 8
.type standalone__gqa_softmax__near_ridge_kernel,@function
standalone__gqa_softmax__near_ridge_kernel:
  s_cmp_ge_u32 s2, 256
  s_cbranch_scc1 L_end
  s_load_dwordx4 s[4:7], s[0:1], 0
  s_load_dwordx4 s[8:11], s[0:1], 16
  v_and_b32 v4, 63, v0
  v_lshrrev_b32 v5, 6, v0
  s_nop 0
  v_readfirstlane_b32 s32, v5
  s_getpc_b64 s[50:51]
L_pc:
  s_lshr_b32 s42, s2, 3
  s_lshl_b32 s42, s42, 2
  s_add_u32 s42, s42, s32
  s_min_u32 s42, s42, (L_end-L_pc)/1024
  s_lshl_b32 s42, s42, 10
  v_lshl_add_u32 v6, v4, 4, s42
  global_load_dwordx4 v[68:71], v6, s[50:51]
  v_lshrrev_b32 v6, 4, v4
  v_lshlrev_b32 v6, 3, v6
  v_bfe_u32 v7, v4, 3, 1
  v_add_u32 v6, v6, v7
  v_lshl_add_u32 v6, v5, 1, v6
  v_mul_u32_u24 v6, 384, v6
  v_and_b32 v7, 7, v4
  v_lshl_add_u32 v2, v7, 4, v6
  v_and_b32 v6, 15, v4
  v_lshrrev_b32 v7, 4, v4
  v_bfe_u32 v8, v6, 1, 2
  v_mul_u32_u24 v8, 1056, v8
  v_lshrrev_b32 v9, 3, v6
  v_lshlrev_b32 v9, 1, v9
  v_and_b32 v0, 1, v6
  v_add_u32 v9, v9, v0
  v_lshl_add_u32 v0, v9, 7, v8
  v_lshl_add_u32 v0, v7, 4, v0
  v_lshrrev_b32 v6, 2, v4
  v_bfe_u32 v8, v6, 1, 2
  v_mul_u32_u24 v8, 1040, v8
  v_lshrrev_b32 v9, 3, v6
  v_lshlrev_b32 v9, 1, v9
  v_and_b32 v1, 1, v6
  v_add_u32 v9, v9, v1
  v_lshl_add_u32 v1, v9, 7, v8
  v_and_b32 v6, 1, v4
  v_lshl_add_u32 v1, v6, 3, v1
  v_bfe_u32 v6, v4, 1, 1
  v_lshl_add_u32 v1, v6, 6, v1
  v_add_u32 v1, 62880, v1
  v_mul_u32_u24 v3, 6144, v5
  v_lshl_add_u32 v3, v4, 4, v3
  v_add_u32 v3, 138336, v3
  v_add_u32 v148, 0, v4
  v_mul_u32_u24 v6, 2731, v148
  v_lshrrev_b32 v6, 16, v6
  v_and_b32 v6, 6, v6
  v_xor_b32 v148, v148, v6
  v_lshlrev_b32 v148, 4, v148
  v_add_u32 v149, 64, v4
  v_mul_u32_u24 v6, 2731, v149
  v_lshrrev_b32 v6, 16, v6
  v_and_b32 v6, 6, v6
  v_xor_b32 v149, v149, v6
  v_lshlrev_b32 v149, 4, v149
  v_add_u32 v150, 128, v4
  v_mul_u32_u24 v6, 2731, v150
  v_lshrrev_b32 v6, 16, v6
  v_and_b32 v6, 6, v6
  v_xor_b32 v150, v150, v6
  v_lshlrev_b32 v150, 4, v150
  v_and_b32 v6, 15, v4
  v_and_b32 v8, 6, v4
  v_xor_b32 v8, v8, v7
  v_mul_u32_u24 v6, 384, v6
  v_lshl_add_u32 v151, v8, 4, v6
  v_xor_b32 v152, 64, v151
  s_and_b32 s3, s2, 7
  s_lshl_b32 s3, s3, 5
  s_lshr_b32 s42, s2, 3
  s_add_u32 s3, s3, s42
  s_mul_i32 s33, s3, 393216
  s_mul_i32 s34, s3, 147456
  s_mov_b32 s18, 393216
  s_mov_b32 s19, 0x20000
  s_mov_b32 s26, 147456
  s_mov_b32 s27, 0x20000
  s_mul_i32 s41, s32, 1056
  s_lshr_b32 s42, s32, 1
  s_mul_i32 s42, s42, 3
  s_add_u32 s42, s42, s32
  s_add_u32 s42, s42, 2
  s_mul_i32 s44, s42, 12576
  s_add_u32 s43, s44, 25152
  s_mul_i32 s42, s32, 36864
  v_add_u32 v148, s42, v148
  v_add_u32 v149, s42, v149
  v_add_u32 v150, s42, v150
  s_waitcnt lgkmcnt(0)
  s_add_u32 s16, s6, s33
  s_addc_u32 s17, s7, 0
  s_add_u32 s24, s4, s34
  s_addc_u32 s25, s5, 0
  s_mov_b32 s42, 0
  s_add_u32 m0, s41, 0
  s_nop 0
  buffer_load_dwordx4 v2, s[16:19], s42 offen offset:0 nt lds
  s_add_u32 m0, s41, 4064
  s_nop 0
  buffer_load_dwordx4 v2, s[16:19], s42 offen offset:128 nt lds
  s_add_u32 m0, s41, 8128
  s_nop 0
  buffer_load_dwordx4 v2, s[16:19], s42 offen offset:256 nt lds
  s_mov_b32 s42, 12288
  s_add_u32 m0, s41, 12576
  s_nop 0
  buffer_load_dwordx4 v2, s[16:19], s42 offen offset:0 nt lds
  s_add_u32 m0, s41, 16640
  s_nop 0
  buffer_load_dwordx4 v2, s[16:19], s42 offen offset:128 nt lds
  s_add_u32 m0, s41, 20704
  s_nop 0
  buffer_load_dwordx4 v2, s[16:19], s42 offen offset:256 nt lds
  s_add_u32 m0, s43, 0
  s_mov_b32 s42, 0
  buffer_load_dwordx4 v148, s[24:27], s42 offen offset:0 nt lds
  buffer_load_dwordx4 v148, s[24:27], s42 offen offset:3072 nt lds
  s_add_u32 m0, s43, 1024
  s_nop 0
  buffer_load_dwordx4 v149, s[24:27], s42 offen offset:0 nt lds
  buffer_load_dwordx4 v149, s[24:27], s42 offen offset:3072 nt lds
  s_add_u32 m0, s43, 2048
  s_nop 0
  buffer_load_dwordx4 v150, s[24:27], s42 offen offset:0 nt lds
  buffer_load_dwordx4 v150, s[24:27], s42 offen offset:3072 nt lds
  s_add_u32 s20, s8, s33
  s_addc_u32 s21, s9, 0
  s_mov_b32 s22, 393216
  s_mov_b32 s23, 0x20000
  s_add_u32 s28, s10, s34
  s_addc_u32 s29, s11, 0
  s_mov_b32 s30, 147456
  s_mov_b32 s31, 0x20000
  s_mov_b32 s40, 0x3dd53b95
  s_mov_b32 s39, 14
  s_lshl_b32 s3, s32, 4
  s_sub_u32 s97, s41, s3
  s_mov_b32 s52, s40
  s_mov_b32 s53, s40
  v_mov_b32 v4, 0
  v_mov_b32 v5, 0
  v_mov_b32 v6, 0
  v_mov_b32 v7, 0
  v_mov_b32 v8, 0
  v_mov_b32 v9, 0
  v_mov_b32 v14, 162912
  v_mov_b32 v15, 0
  ds_write_b32 v14, v15 offset:0
  s_add_u32 m0, s43, 6144
  s_mov_b32 s42, 6144
  buffer_load_dwordx4 v148, s[24:27], s42 offen offset:0 nt lds
  buffer_load_dwordx4 v148, s[24:27], s42 offen offset:3072 nt lds
  s_add_u32 m0, s43, 7168
  s_nop 0
  buffer_load_dwordx4 v149, s[24:27], s42 offen offset:0 nt lds
  buffer_load_dwordx4 v149, s[24:27], s42 offen offset:3072 nt lds
  s_add_u32 m0, s43, 8192
  s_nop 0
  buffer_load_dwordx4 v150, s[24:27], s42 offen offset:0 nt lds
  buffer_load_dwordx4 v150, s[24:27], s42 offen offset:3072 nt lds
  s_add_u32 m0, s44, 0
  s_mov_b32 s42, 12288
  buffer_load_dwordx4 v148, s[24:27], s42 offen offset:0 nt lds
  buffer_load_dwordx4 v148, s[24:27], s42 offen offset:3072 nt lds
  s_add_u32 m0, s44, 1024
  s_nop 0
  buffer_load_dwordx4 v149, s[24:27], s42 offen offset:0 nt lds
  buffer_load_dwordx4 v149, s[24:27], s42 offen offset:3072 nt lds
  s_add_u32 m0, s44, 2048
  s_nop 0
  buffer_load_dwordx4 v150, s[24:27], s42 offen offset:0 nt lds
  buffer_load_dwordx4 v150, s[24:27], s42 offen offset:3072 nt lds
  s_waitcnt vmcnt(12)
  v_add_u32 v10, s43, v151
  v_add_u32 v11, s43, v152
  ds_read_b128 v[68:71], v10 offset:0
  ds_read_b128 v[72:75], v11 offset:0
  ds_read_b128 v[76:79], v10 offset:128
  ds_read_b128 v[80:83], v11 offset:128
  ds_read_b128 v[84:87], v10 offset:256
  ds_read_b128 v[88:91], v11 offset:256
  s_barrier
  ds_read_b128 a[124:127], v0 offset:0
  ds_read_b128 a[128:131], v0 offset:64
  ds_read_b128 a[132:135], v0 offset:4192
  ds_read_b128 a[136:139], v0 offset:4256
  ds_read_b128 a[140:143], v0 offset:8384
  ds_read_b128 a[144:147], v0 offset:8448
  ds_read_b128 v[164:167], v0 offset:512
  ds_read_b128 v[168:171], v0 offset:576
  ds_read_b128 v[172:175], v0 offset:4704
  ds_read_b128 v[176:179], v0 offset:4768
  ds_read_b128 v[180:183], v0 offset:8896
  ds_read_b128 v[184:187], v0 offset:8960
  ds_read_b128 v[188:191], v0 offset:12576
  ds_read_b128 v[192:195], v0 offset:12640
  ds_read_b128 v[196:199], v0 offset:16768
  ds_read_b128 v[200:203], v0 offset:16832
  ds_read_b128 v[204:207], v0 offset:20960
  ds_read_b128 v[208:211], v0 offset:21024
  ds_read_b128 v[212:215], v0 offset:13088
  ds_read_b128 v[216:219], v0 offset:13152
  ds_read_b128 v[220:223], v0 offset:17280
  ds_read_b128 v[224:227], v0 offset:17344
  ds_read_b128 v[228:231], v0 offset:21472
  ds_read_b128 v[232:235], v0 offset:21536
  s_add_u32 m0, s44, 6144
  s_mov_b32 s42, 18432
  buffer_load_dwordx4 v148, s[24:27], s42 offen offset:0 nt lds
  buffer_load_dwordx4 v148, s[24:27], s42 offen offset:3072 nt lds
  s_add_u32 m0, s44, 7168
  s_nop 0
  buffer_load_dwordx4 v149, s[24:27], s42 offen offset:0 nt lds
  buffer_load_dwordx4 v149, s[24:27], s42 offen offset:3072 nt lds
  s_add_u32 m0, s44, 8192
  s_nop 0
  buffer_load_dwordx4 v150, s[24:27], s42 offen offset:0 nt lds
  buffer_load_dwordx4 v150, s[24:27], s42 offen offset:3072 nt lds
  s_waitcnt lgkmcnt(15)
  v_lshlrev_b32 v116, 16, v68
  v_and_b32 v68, 0xffff0000, v68
  v_lshlrev_b32 v117, 16, v69
  v_and_b32 v69, 0xffff0000, v69
  v_lshlrev_b32 v118, 16, v70
  v_and_b32 v70, 0xffff0000, v70
  v_lshlrev_b32 v119, 16, v71
  v_and_b32 v71, 0xffff0000, v71
  v_lshlrev_b32 v120, 16, v72
  v_and_b32 v72, 0xffff0000, v72
  v_lshlrev_b32 v121, 16, v73
  v_and_b32 v73, 0xffff0000, v73
  v_lshlrev_b32 v122, 16, v74
  v_and_b32 v74, 0xffff0000, v74
  v_lshlrev_b32 v123, 16, v75
  v_and_b32 v75, 0xffff0000, v75
  v_lshlrev_b32 v124, 16, v76
  v_and_b32 v76, 0xffff0000, v76
  v_lshlrev_b32 v125, 16, v77
  v_and_b32 v77, 0xffff0000, v77
  v_lshlrev_b32 v126, 16, v78
  v_and_b32 v78, 0xffff0000, v78
  v_lshlrev_b32 v127, 16, v79
  v_and_b32 v79, 0xffff0000, v79
  v_lshlrev_b32 v128, 16, v80
  v_and_b32 v80, 0xffff0000, v80
  v_lshlrev_b32 v129, 16, v81
  v_and_b32 v81, 0xffff0000, v81
  v_lshlrev_b32 v130, 16, v82
  v_and_b32 v82, 0xffff0000, v82
  v_lshlrev_b32 v131, 16, v83
  v_and_b32 v83, 0xffff0000, v83
  v_lshlrev_b32 v132, 16, v84
  v_and_b32 v84, 0xffff0000, v84
  v_lshlrev_b32 v133, 16, v85
  v_and_b32 v85, 0xffff0000, v85
  v_lshlrev_b32 v134, 16, v86
  v_and_b32 v86, 0xffff0000, v86
  v_lshlrev_b32 v135, 16, v87
  v_and_b32 v87, 0xffff0000, v87
  v_lshlrev_b32 v136, 16, v88
  v_and_b32 v88, 0xffff0000, v88
  v_lshlrev_b32 v137, 16, v89
  v_and_b32 v89, 0xffff0000, v89
  v_lshlrev_b32 v138, 16, v90
  v_and_b32 v90, 0xffff0000, v90
  v_lshlrev_b32 v139, 16, v91
  v_and_b32 v91, 0xffff0000, v91
  v_pk_mul_f32 v[116:117], v[116:117], s[52:53]
  v_pk_mul_f32 v[118:119], v[118:119], s[52:53]
  v_pk_mul_f32 v[120:121], v[120:121], s[52:53]
  v_pk_mul_f32 v[122:123], v[122:123], s[52:53]
  v_pk_mul_f32 v[124:125], v[124:125], s[52:53]
  v_pk_mul_f32 v[126:127], v[126:127], s[52:53]
  v_pk_mul_f32 v[128:129], v[128:129], s[52:53]
  v_pk_mul_f32 v[130:131], v[130:131], s[52:53]
  v_pk_mul_f32 v[132:133], v[132:133], s[52:53]
  v_pk_mul_f32 v[134:135], v[134:135], s[52:53]
  v_pk_mul_f32 v[136:137], v[136:137], s[52:53]
  v_pk_mul_f32 v[138:139], v[138:139], s[52:53]
  v_pk_mul_f32 v[68:69], v[68:69], s[52:53]
  v_pk_mul_f32 v[70:71], v[70:71], s[52:53]
  v_pk_mul_f32 v[72:73], v[72:73], s[52:53]
  v_pk_mul_f32 v[74:75], v[74:75], s[52:53]
  v_pk_mul_f32 v[76:77], v[76:77], s[52:53]
  v_pk_mul_f32 v[78:79], v[78:79], s[52:53]
  v_pk_mul_f32 v[80:81], v[80:81], s[52:53]
  v_pk_mul_f32 v[82:83], v[82:83], s[52:53]
  v_pk_mul_f32 v[84:85], v[84:85], s[52:53]
  v_pk_mul_f32 v[86:87], v[86:87], s[52:53]
  v_pk_mul_f32 v[88:89], v[88:89], s[52:53]
  v_pk_mul_f32 v[90:91], v[90:91], s[52:53]
  v_cvt_pk_bf16_f32 v68, v116, v68
  v_cvt_pk_bf16_f32 v69, v117, v69
  v_cvt_pk_bf16_f32 v70, v118, v70
  v_cvt_pk_bf16_f32 v71, v119, v71
  v_accvgpr_write_b32 a0, v68
  v_accvgpr_write_b32 a1, v69
  v_accvgpr_write_b32 a2, v70
  v_accvgpr_write_b32 a3, v71
  v_cvt_pk_bf16_f32 v72, v120, v72
  v_cvt_pk_bf16_f32 v73, v121, v73
  v_cvt_pk_bf16_f32 v74, v122, v74
  v_cvt_pk_bf16_f32 v75, v123, v75
  v_accvgpr_write_b32 a4, v72
  v_accvgpr_write_b32 a5, v73
  v_accvgpr_write_b32 a6, v74
  v_accvgpr_write_b32 a7, v75
  v_cvt_pk_bf16_f32 v76, v124, v76
  v_cvt_pk_bf16_f32 v77, v125, v77
  v_cvt_pk_bf16_f32 v78, v126, v78
  v_cvt_pk_bf16_f32 v79, v127, v79
  v_accvgpr_write_b32 a8, v76
  v_accvgpr_write_b32 a9, v77
  v_accvgpr_write_b32 a10, v78
  v_accvgpr_write_b32 a11, v79
  v_cvt_pk_bf16_f32 v80, v128, v80
  v_cvt_pk_bf16_f32 v81, v129, v81
  v_cvt_pk_bf16_f32 v82, v130, v82
  v_cvt_pk_bf16_f32 v83, v131, v83
  v_accvgpr_write_b32 a12, v80
  v_accvgpr_write_b32 a13, v81
  v_accvgpr_write_b32 a14, v82
  v_accvgpr_write_b32 a15, v83
  v_cvt_pk_bf16_f32 v84, v132, v84
  v_cvt_pk_bf16_f32 v85, v133, v85
  v_cvt_pk_bf16_f32 v86, v134, v86
  v_cvt_pk_bf16_f32 v87, v135, v87
  v_accvgpr_write_b32 a16, v84
  v_accvgpr_write_b32 a17, v85
  v_accvgpr_write_b32 a18, v86
  v_accvgpr_write_b32 a19, v87
  v_cvt_pk_bf16_f32 v140, v136, v88
  v_cvt_pk_bf16_f32 v141, v137, v89
  v_cvt_pk_bf16_f32 v142, v138, v90
  v_cvt_pk_bf16_f32 v143, v139, v91
  ds_write_b128 v3, v[140:143] offset:0
  s_waitcnt vmcnt(12)
  v_add_u32 v10, s43, v151
  v_add_u32 v11, s43, v152
  ds_read_b128 v[92:95], v10 offset:6144
  ds_read_b128 v[96:99], v11 offset:6144
  ds_read_b128 v[100:103], v10 offset:6272
  ds_read_b128 v[104:107], v11 offset:6272
  ds_read_b128 v[108:111], v10 offset:6400
  ds_read_b128 v[112:115], v11 offset:6400
  v_mfma_f32_16x16x32_bf16 v[156:159], a[124:127], a[0:3], -4.0
  s_add_u32 m0, s43, 0
  s_mov_b32 s42, 24576
  buffer_load_dwordx4 v148, s[24:27], s42 offen offset:0 nt lds
  v_mfma_f32_16x16x32_bf16 v[156:159], a[128:131], a[4:7], v[156:159]
  s_nop 0
  buffer_load_dwordx4 v148, s[24:27], s42 offen offset:3072 nt lds
  s_add_u32 m0, s43, 1024
  v_mfma_f32_16x16x32_bf16 v[156:159], a[132:135], a[8:11], v[156:159]
  buffer_load_dwordx4 v149, s[24:27], s42 offen offset:0 nt lds
  v_mfma_f32_16x16x32_bf16 v[156:159], a[136:139], a[12:15], v[156:159]
  s_nop 0
  buffer_load_dwordx4 v149, s[24:27], s42 offen offset:3072 nt lds
  s_add_u32 m0, s43, 2048
  v_mfma_f32_16x16x32_bf16 v[156:159], a[140:143], a[16:19], v[156:159]
  s_waitcnt lgkmcnt(5)
  buffer_load_dwordx4 v150, s[24:27], s42 offen offset:0 nt lds
  v_lshlrev_b32 v116, 16, v92
  v_mfma_f32_16x16x32_bf16 v[156:159], a[144:147], v[140:143], v[156:159]
  buffer_load_dwordx4 v150, s[24:27], s42 offen offset:3072 nt lds
  v_and_b32 v92, 0xffff0000, v92
  v_mfma_f32_16x16x32_bf16 v[160:163], v[164:167], a[0:3], -4.0
  v_lshlrev_b32 v117, 16, v93
  v_and_b32 v93, 0xffff0000, v93
  v_mfma_f32_16x16x32_bf16 v[160:163], v[168:171], a[4:7], v[160:163]
  v_lshlrev_b32 v118, 16, v94
  v_and_b32 v94, 0xffff0000, v94
  v_mfma_f32_16x16x32_bf16 v[160:163], v[172:175], a[8:11], v[160:163]
  v_exp_f32 v156, v156
  v_mfma_f32_16x16x32_bf16 v[160:163], v[176:179], a[12:15], v[160:163]
  v_exp_f32 v157, v157
  v_mfma_f32_16x16x32_bf16 v[160:163], v[180:183], a[16:19], v[160:163]
  v_exp_f32 v158, v158
  v_mfma_f32_16x16x32_bf16 v[160:163], v[184:187], v[140:143], v[160:163]
  v_exp_f32 v159, v159
  v_mfma_f32_16x16x32_bf16 v[12:15], v[188:191], a[0:3], -4.0
  v_cvt_pk_bf16_f32 v20, v156, v157
  v_add_f32 v4, v156, v4
  v_mfma_f32_16x16x32_bf16 v[12:15], v[192:195], a[4:7], v[12:15]
  v_cvt_pk_bf16_f32 v21, v158, v159
  v_add_f32 v4, v157, v4
  v_mfma_f32_16x16x32_bf16 v[12:15], v[196:199], a[8:11], v[12:15]
  v_add_f32 v4, v158, v4
  v_add_f32 v4, v159, v4
  v_mfma_f32_16x16x32_bf16 v[12:15], v[200:203], a[12:15], v[12:15]
  v_exp_f32 v160, v160
  v_mfma_f32_16x16x32_bf16 v[12:15], v[204:207], a[16:19], v[12:15]
  v_exp_f32 v161, v161
  v_mfma_f32_16x16x32_bf16 v[12:15], v[208:211], v[140:143], v[12:15]
  v_exp_f32 v162, v162
  v_mfma_f32_16x16x32_bf16 v[16:19], v[212:215], a[0:3], -4.0
  v_exp_f32 v163, v163
  v_mfma_f32_16x16x32_bf16 v[16:19], v[216:219], a[4:7], v[16:19]
  v_cvt_pk_bf16_f32 v22, v160, v161
  v_add_f32 v4, v160, v4
  v_mfma_f32_16x16x32_bf16 v[16:19], v[220:223], a[8:11], v[16:19]
  s_waitcnt lgkmcnt(1)
  v_cvt_pk_bf16_f32 v23, v162, v163
  v_add_f32 v4, v161, v4
  v_mfma_f32_16x16x32_bf16 v[16:19], v[224:227], a[12:15], v[16:19]
  s_waitcnt lgkmcnt(2)
  v_add_f32 v4, v162, v4
  v_add_f32 v4, v163, v4
  v_mfma_f32_16x16x32_bf16 v[16:19], v[228:231], a[16:19], v[16:19]
  s_waitcnt lgkmcnt(3)
  v_lshlrev_b32 v119, 16, v95
  v_and_b32 v95, 0xffff0000, v95
  v_mfma_f32_16x16x32_bf16 v[16:19], v[232:235], v[140:143], v[16:19]
  s_waitcnt lgkmcnt(0)
  s_waitcnt lgkmcnt(4)
  v_lshlrev_b32 v120, 16, v96
  v_and_b32 v96, 0xffff0000, v96
  v_lshlrev_b32 v121, 16, v97
  v_and_b32 v97, 0xffff0000, v97
  v_lshlrev_b32 v122, 16, v98
  v_and_b32 v98, 0xffff0000, v98
  v_lshlrev_b32 v123, 16, v99
  v_and_b32 v99, 0xffff0000, v99
  v_lshlrev_b32 v124, 16, v100
  v_and_b32 v100, 0xffff0000, v100
  v_lshlrev_b32 v125, 16, v101
  v_and_b32 v101, 0xffff0000, v101
  v_lshlrev_b32 v126, 16, v102
  v_and_b32 v102, 0xffff0000, v102
  v_lshlrev_b32 v127, 16, v103
  v_and_b32 v103, 0xffff0000, v103
  v_lshlrev_b32 v128, 16, v104
  v_and_b32 v104, 0xffff0000, v104
  v_lshlrev_b32 v129, 16, v105
  v_and_b32 v105, 0xffff0000, v105
  v_lshlrev_b32 v130, 16, v106
  v_and_b32 v106, 0xffff0000, v106
  v_lshlrev_b32 v131, 16, v107
  v_and_b32 v107, 0xffff0000, v107
  v_lshlrev_b32 v132, 16, v108
  v_and_b32 v108, 0xffff0000, v108
  v_lshlrev_b32 v133, 16, v109
  v_and_b32 v109, 0xffff0000, v109
  v_lshlrev_b32 v134, 16, v110
  v_and_b32 v110, 0xffff0000, v110
  v_lshlrev_b32 v135, 16, v111
  v_and_b32 v111, 0xffff0000, v111
  v_lshlrev_b32 v136, 16, v112
  v_and_b32 v112, 0xffff0000, v112
  v_lshlrev_b32 v137, 16, v113
  v_and_b32 v113, 0xffff0000, v113
  v_lshlrev_b32 v138, 16, v114
  v_and_b32 v114, 0xffff0000, v114
  v_lshlrev_b32 v139, 16, v115
  v_and_b32 v115, 0xffff0000, v115
  v_exp_f32 v12, v12
  v_exp_f32 v13, v13
  v_exp_f32 v14, v14
  v_exp_f32 v15, v15
  v_exp_f32 v16, v16
  v_exp_f32 v17, v17
  v_exp_f32 v18, v18
  v_exp_f32 v19, v19
  v_pk_mul_f32 v[116:117], v[116:117], s[52:53]
  v_pk_mul_f32 v[118:119], v[118:119], s[52:53]
  v_pk_mul_f32 v[120:121], v[120:121], s[52:53]
  v_pk_mul_f32 v[122:123], v[122:123], s[52:53]
  v_pk_mul_f32 v[124:125], v[124:125], s[52:53]
  v_pk_mul_f32 v[126:127], v[126:127], s[52:53]
  v_pk_mul_f32 v[128:129], v[128:129], s[52:53]
  v_pk_mul_f32 v[130:131], v[130:131], s[52:53]
  v_pk_mul_f32 v[132:133], v[132:133], s[52:53]
  v_pk_mul_f32 v[134:135], v[134:135], s[52:53]
  v_pk_mul_f32 v[136:137], v[136:137], s[52:53]
  v_pk_mul_f32 v[138:139], v[138:139], s[52:53]
  v_pk_mul_f32 v[92:93], v[92:93], s[52:53]
  v_pk_mul_f32 v[94:95], v[94:95], s[52:53]
  v_pk_mul_f32 v[96:97], v[96:97], s[52:53]
  v_pk_mul_f32 v[98:99], v[98:99], s[52:53]
  v_pk_mul_f32 v[100:101], v[100:101], s[52:53]
  v_pk_mul_f32 v[102:103], v[102:103], s[52:53]
  v_pk_mul_f32 v[104:105], v[104:105], s[52:53]
  v_pk_mul_f32 v[106:107], v[106:107], s[52:53]
  v_pk_mul_f32 v[108:109], v[108:109], s[52:53]
  v_pk_mul_f32 v[110:111], v[110:111], s[52:53]
  v_pk_mul_f32 v[112:113], v[112:113], s[52:53]
  v_pk_mul_f32 v[114:115], v[114:115], s[52:53]
  v_cvt_pk_bf16_f32 v44, v12, v13
  v_add_f32 v4, v12, v4
  v_cvt_pk_bf16_f32 v45, v14, v15
  v_add_f32 v4, v13, v4
  v_add_f32 v4, v14, v4
  v_add_f32 v4, v15, v4
  v_cvt_pk_bf16_f32 v46, v16, v17
  v_add_f32 v4, v16, v4
  v_cvt_pk_bf16_f32 v47, v18, v19
  v_add_f32 v4, v17, v4
  v_add_f32 v4, v18, v4
  v_add_f32 v4, v19, v4
  v_cvt_pk_bf16_f32 v92, v116, v92
  v_cvt_pk_bf16_f32 v93, v117, v93
  v_cvt_pk_bf16_f32 v94, v118, v94
  v_cvt_pk_bf16_f32 v95, v119, v95
  v_accvgpr_write_b32 a20, v92
  v_accvgpr_write_b32 a21, v93
  v_accvgpr_write_b32 a22, v94
  v_accvgpr_write_b32 a23, v95
  v_cvt_pk_bf16_f32 v96, v120, v96
  v_cvt_pk_bf16_f32 v97, v121, v97
  v_cvt_pk_bf16_f32 v98, v122, v98
  v_cvt_pk_bf16_f32 v99, v123, v99
  v_accvgpr_write_b32 a24, v96
  v_accvgpr_write_b32 a25, v97
  v_accvgpr_write_b32 a26, v98
  v_accvgpr_write_b32 a27, v99
  v_cvt_pk_bf16_f32 v100, v124, v100
  v_cvt_pk_bf16_f32 v101, v125, v101
  v_cvt_pk_bf16_f32 v102, v126, v102
  v_cvt_pk_bf16_f32 v103, v127, v103
  v_accvgpr_write_b32 a28, v100
  v_accvgpr_write_b32 a29, v101
  v_accvgpr_write_b32 a30, v102
  v_accvgpr_write_b32 a31, v103
  v_cvt_pk_bf16_f32 v104, v128, v104
  v_cvt_pk_bf16_f32 v105, v129, v105
  v_cvt_pk_bf16_f32 v106, v130, v106
  v_cvt_pk_bf16_f32 v107, v131, v107
  v_accvgpr_write_b32 a32, v104
  v_accvgpr_write_b32 a33, v105
  v_accvgpr_write_b32 a34, v106
  v_accvgpr_write_b32 a35, v107
  v_cvt_pk_bf16_f32 v108, v132, v108
  v_cvt_pk_bf16_f32 v109, v133, v109
  v_cvt_pk_bf16_f32 v110, v134, v110
  v_cvt_pk_bf16_f32 v111, v135, v111
  v_accvgpr_write_b32 a36, v108
  v_accvgpr_write_b32 a37, v109
  v_accvgpr_write_b32 a38, v110
  v_accvgpr_write_b32 a39, v111
  v_cvt_pk_bf16_f32 v144, v136, v112
  v_cvt_pk_bf16_f32 v145, v137, v113
  v_cvt_pk_bf16_f32 v146, v138, v114
  v_cvt_pk_bf16_f32 v147, v139, v115
  ds_write_b128 v3, v[144:147] offset:1024
  s_waitcnt vmcnt(12)
  v_add_u32 v10, s44, v151
  v_add_u32 v11, s44, v152
  ds_read_b128 v[68:71], v10 offset:0
  ds_read_b128 v[72:75], v11 offset:0
  ds_read_b128 v[76:79], v10 offset:128
  ds_read_b128 v[80:83], v11 offset:128
  ds_read_b128 v[84:87], v10 offset:256
  ds_read_b128 v[88:91], v11 offset:256
  v_mfma_f32_16x16x32_bf16 v[156:159], a[124:127], a[20:23], -4.0
  s_add_u32 m0, s43, 6144
  s_mov_b32 s42, 30720
  buffer_load_dwordx4 v148, s[24:27], s42 offen offset:0 nt lds
  v_mfma_f32_16x16x32_bf16 v[156:159], a[128:131], a[24:27], v[156:159]
  s_nop 0
  buffer_load_dwordx4 v148, s[24:27], s42 offen offset:3072 nt lds
  s_add_u32 m0, s43, 7168
  v_mfma_f32_16x16x32_bf16 v[156:159], a[132:135], a[28:31], v[156:159]
  buffer_load_dwordx4 v149, s[24:27], s42 offen offset:0 nt lds
  v_mfma_f32_16x16x32_bf16 v[156:159], a[136:139], a[32:35], v[156:159]
  s_nop 0
  buffer_load_dwordx4 v149, s[24:27], s42 offen offset:3072 nt lds
  s_add_u32 m0, s43, 8192
  v_mfma_f32_16x16x32_bf16 v[156:159], a[140:143], a[36:39], v[156:159]
  s_waitcnt lgkmcnt(5)
  buffer_load_dwordx4 v150, s[24:27], s42 offen offset:0 nt lds
  v_lshlrev_b32 v116, 16, v68
  v_mfma_f32_16x16x32_bf16 v[156:159], a[144:147], v[144:147], v[156:159]
  buffer_load_dwordx4 v150, s[24:27], s42 offen offset:3072 nt lds
  v_and_b32 v68, 0xffff0000, v68
  v_mfma_f32_16x16x32_bf16 v[160:163], v[164:167], a[20:23], -4.0
  v_lshlrev_b32 v117, 16, v69
  v_and_b32 v69, 0xffff0000, v69
  v_mfma_f32_16x16x32_bf16 v[160:163], v[168:171], a[24:27], v[160:163]
  v_lshlrev_b32 v118, 16, v70
  v_and_b32 v70, 0xffff0000, v70
  v_mfma_f32_16x16x32_bf16 v[160:163], v[172:175], a[28:31], v[160:163]
  v_exp_f32 v156, v156
  v_mfma_f32_16x16x32_bf16 v[160:163], v[176:179], a[32:35], v[160:163]
  v_exp_f32 v157, v157
  v_mfma_f32_16x16x32_bf16 v[160:163], v[180:183], a[36:39], v[160:163]
  v_exp_f32 v158, v158
  v_mfma_f32_16x16x32_bf16 v[160:163], v[184:187], v[144:147], v[160:163]
  v_exp_f32 v159, v159
  v_mfma_f32_16x16x32_bf16 v[12:15], v[188:191], a[20:23], -4.0
  v_cvt_pk_bf16_f32 v24, v156, v157
  v_add_f32 v5, v156, v5
  v_mfma_f32_16x16x32_bf16 v[12:15], v[192:195], a[24:27], v[12:15]
  v_cvt_pk_bf16_f32 v25, v158, v159
  v_add_f32 v5, v157, v5
  v_mfma_f32_16x16x32_bf16 v[12:15], v[196:199], a[28:31], v[12:15]
  v_add_f32 v5, v158, v5
  v_add_f32 v5, v159, v5
  v_mfma_f32_16x16x32_bf16 v[12:15], v[200:203], a[32:35], v[12:15]
  v_exp_f32 v160, v160
  v_mfma_f32_16x16x32_bf16 v[12:15], v[204:207], a[36:39], v[12:15]
  v_exp_f32 v161, v161
  v_mfma_f32_16x16x32_bf16 v[12:15], v[208:211], v[144:147], v[12:15]
  v_exp_f32 v162, v162
  v_mfma_f32_16x16x32_bf16 v[16:19], v[212:215], a[20:23], -4.0
  v_exp_f32 v163, v163
  v_mfma_f32_16x16x32_bf16 v[16:19], v[216:219], a[24:27], v[16:19]
  v_cvt_pk_bf16_f32 v26, v160, v161
  v_add_f32 v5, v160, v5
  v_mfma_f32_16x16x32_bf16 v[16:19], v[220:223], a[28:31], v[16:19]
  s_waitcnt lgkmcnt(1)
  v_cvt_pk_bf16_f32 v27, v162, v163
  v_add_f32 v5, v161, v5
  v_mfma_f32_16x16x32_bf16 v[16:19], v[224:227], a[32:35], v[16:19]
  s_waitcnt lgkmcnt(2)
  v_add_f32 v5, v162, v5
  v_add_f32 v5, v163, v5
  v_mfma_f32_16x16x32_bf16 v[16:19], v[228:231], a[36:39], v[16:19]
  s_waitcnt lgkmcnt(3)
  v_lshlrev_b32 v119, 16, v71
  v_and_b32 v71, 0xffff0000, v71
  v_mfma_f32_16x16x32_bf16 v[16:19], v[232:235], v[144:147], v[16:19]
  s_waitcnt lgkmcnt(0)
  s_waitcnt lgkmcnt(4)
  v_lshlrev_b32 v120, 16, v72
  v_and_b32 v72, 0xffff0000, v72
  v_lshlrev_b32 v121, 16, v73
  v_and_b32 v73, 0xffff0000, v73
  v_lshlrev_b32 v122, 16, v74
  v_and_b32 v74, 0xffff0000, v74
  v_lshlrev_b32 v123, 16, v75
  v_and_b32 v75, 0xffff0000, v75
  v_lshlrev_b32 v124, 16, v76
  v_and_b32 v76, 0xffff0000, v76
  v_lshlrev_b32 v125, 16, v77
  v_and_b32 v77, 0xffff0000, v77
  v_lshlrev_b32 v126, 16, v78
  v_and_b32 v78, 0xffff0000, v78
  v_lshlrev_b32 v127, 16, v79
  v_and_b32 v79, 0xffff0000, v79
  v_lshlrev_b32 v128, 16, v80
  v_and_b32 v80, 0xffff0000, v80
  v_lshlrev_b32 v129, 16, v81
  v_and_b32 v81, 0xffff0000, v81
  v_lshlrev_b32 v130, 16, v82
  v_and_b32 v82, 0xffff0000, v82
  v_lshlrev_b32 v131, 16, v83
  v_and_b32 v83, 0xffff0000, v83
  v_lshlrev_b32 v132, 16, v84
  v_and_b32 v84, 0xffff0000, v84
  v_lshlrev_b32 v133, 16, v85
  v_and_b32 v85, 0xffff0000, v85
  v_lshlrev_b32 v134, 16, v86
  v_and_b32 v86, 0xffff0000, v86
  v_lshlrev_b32 v135, 16, v87
  v_and_b32 v87, 0xffff0000, v87
  v_lshlrev_b32 v136, 16, v88
  v_and_b32 v88, 0xffff0000, v88
  v_lshlrev_b32 v137, 16, v89
  v_and_b32 v89, 0xffff0000, v89
  v_lshlrev_b32 v138, 16, v90
  v_and_b32 v90, 0xffff0000, v90
  v_lshlrev_b32 v139, 16, v91
  v_and_b32 v91, 0xffff0000, v91
  v_exp_f32 v12, v12
  v_exp_f32 v13, v13
  v_exp_f32 v14, v14
  v_exp_f32 v15, v15
  v_exp_f32 v16, v16
  v_exp_f32 v17, v17
  v_exp_f32 v18, v18
  v_exp_f32 v19, v19
  v_pk_mul_f32 v[116:117], v[116:117], s[52:53]
  v_pk_mul_f32 v[118:119], v[118:119], s[52:53]
  v_pk_mul_f32 v[120:121], v[120:121], s[52:53]
  v_pk_mul_f32 v[122:123], v[122:123], s[52:53]
  v_pk_mul_f32 v[124:125], v[124:125], s[52:53]
  v_pk_mul_f32 v[126:127], v[126:127], s[52:53]
  v_pk_mul_f32 v[128:129], v[128:129], s[52:53]
  v_pk_mul_f32 v[130:131], v[130:131], s[52:53]
  v_pk_mul_f32 v[132:133], v[132:133], s[52:53]
  v_pk_mul_f32 v[134:135], v[134:135], s[52:53]
  v_pk_mul_f32 v[136:137], v[136:137], s[52:53]
  v_pk_mul_f32 v[138:139], v[138:139], s[52:53]
  v_pk_mul_f32 v[68:69], v[68:69], s[52:53]
  v_pk_mul_f32 v[70:71], v[70:71], s[52:53]
  v_pk_mul_f32 v[72:73], v[72:73], s[52:53]
  v_pk_mul_f32 v[74:75], v[74:75], s[52:53]
  v_pk_mul_f32 v[76:77], v[76:77], s[52:53]
  v_pk_mul_f32 v[78:79], v[78:79], s[52:53]
  v_pk_mul_f32 v[80:81], v[80:81], s[52:53]
  v_pk_mul_f32 v[82:83], v[82:83], s[52:53]
  v_pk_mul_f32 v[84:85], v[84:85], s[52:53]
  v_pk_mul_f32 v[86:87], v[86:87], s[52:53]
  v_pk_mul_f32 v[88:89], v[88:89], s[52:53]
  v_pk_mul_f32 v[90:91], v[90:91], s[52:53]
  v_cvt_pk_bf16_f32 v48, v12, v13
  v_add_f32 v5, v12, v5
  v_cvt_pk_bf16_f32 v49, v14, v15
  v_add_f32 v5, v13, v5
  v_add_f32 v5, v14, v5
  v_add_f32 v5, v15, v5
  v_cvt_pk_bf16_f32 v50, v16, v17
  v_add_f32 v5, v16, v5
  v_cvt_pk_bf16_f32 v51, v18, v19
  v_add_f32 v5, v17, v5
  v_add_f32 v5, v18, v5
  v_add_f32 v5, v19, v5
  v_cvt_pk_bf16_f32 v68, v116, v68
  v_cvt_pk_bf16_f32 v69, v117, v69
  v_cvt_pk_bf16_f32 v70, v118, v70
  v_cvt_pk_bf16_f32 v71, v119, v71
  v_accvgpr_write_b32 a40, v68
  v_accvgpr_write_b32 a41, v69
  v_accvgpr_write_b32 a42, v70
  v_accvgpr_write_b32 a43, v71
  v_cvt_pk_bf16_f32 v72, v120, v72
  v_cvt_pk_bf16_f32 v73, v121, v73
  v_cvt_pk_bf16_f32 v74, v122, v74
  v_cvt_pk_bf16_f32 v75, v123, v75
  v_accvgpr_write_b32 a44, v72
  v_accvgpr_write_b32 a45, v73
  v_accvgpr_write_b32 a46, v74
  v_accvgpr_write_b32 a47, v75
  v_cvt_pk_bf16_f32 v76, v124, v76
  v_cvt_pk_bf16_f32 v77, v125, v77
  v_cvt_pk_bf16_f32 v78, v126, v78
  v_cvt_pk_bf16_f32 v79, v127, v79
  v_accvgpr_write_b32 a48, v76
  v_accvgpr_write_b32 a49, v77
  v_accvgpr_write_b32 a50, v78
  v_accvgpr_write_b32 a51, v79
  v_cvt_pk_bf16_f32 v80, v128, v80
  v_cvt_pk_bf16_f32 v81, v129, v81
  v_cvt_pk_bf16_f32 v82, v130, v82
  v_cvt_pk_bf16_f32 v83, v131, v83
  v_accvgpr_write_b32 a52, v80
  v_accvgpr_write_b32 a53, v81
  v_accvgpr_write_b32 a54, v82
  v_accvgpr_write_b32 a55, v83
  v_cvt_pk_bf16_f32 v84, v132, v84
  v_cvt_pk_bf16_f32 v85, v133, v85
  v_cvt_pk_bf16_f32 v86, v134, v86
  v_cvt_pk_bf16_f32 v87, v135, v87
  v_accvgpr_write_b32 a56, v84
  v_accvgpr_write_b32 a57, v85
  v_accvgpr_write_b32 a58, v86
  v_accvgpr_write_b32 a59, v87
  v_cvt_pk_bf16_f32 v140, v136, v88
  v_cvt_pk_bf16_f32 v141, v137, v89
  v_cvt_pk_bf16_f32 v142, v138, v90
  v_cvt_pk_bf16_f32 v143, v139, v91
  ds_write_b128 v3, v[140:143] offset:2048
  s_waitcnt vmcnt(12)
  v_add_u32 v10, s44, v151
  v_add_u32 v11, s44, v152
  ds_read_b128 v[92:95], v10 offset:6144
  ds_read_b128 v[96:99], v11 offset:6144
  ds_read_b128 v[100:103], v10 offset:6272
  ds_read_b128 v[104:107], v11 offset:6272
  ds_read_b128 v[108:111], v10 offset:6400
  ds_read_b128 v[112:115], v11 offset:6400
  s_waitcnt lgkmcnt(0)
  s_barrier
  v_mfma_f32_16x16x32_bf16 v[156:159], a[124:127], a[40:43], -4.0
  v_mfma_f32_16x16x32_bf16 v[156:159], a[128:131], a[44:47], v[156:159]
  v_mfma_f32_16x16x32_bf16 v[156:159], a[132:135], a[48:51], v[156:159]
  v_mfma_f32_16x16x32_bf16 v[156:159], a[136:139], a[52:55], v[156:159]
  v_mfma_f32_16x16x32_bf16 v[156:159], a[140:143], a[56:59], v[156:159]
  v_lshlrev_b32 v116, 16, v92
  v_and_b32 v92, 0xffff0000, v92
  v_mfma_f32_16x16x32_bf16 v[156:159], a[144:147], v[140:143], v[156:159]
  v_lshlrev_b32 v117, 16, v93
  v_and_b32 v93, 0xffff0000, v93
  v_mfma_f32_16x16x32_bf16 v[160:163], v[164:167], a[40:43], -4.0
  v_lshlrev_b32 v118, 16, v94
  v_and_b32 v94, 0xffff0000, v94
  v_mfma_f32_16x16x32_bf16 v[160:163], v[168:171], a[44:47], v[160:163]
  v_lshlrev_b32 v119, 16, v95
  v_and_b32 v95, 0xffff0000, v95
  v_mfma_f32_16x16x32_bf16 v[160:163], v[172:175], a[48:51], v[160:163]
  v_exp_f32 v156, v156
  v_mfma_f32_16x16x32_bf16 v[160:163], v[176:179], a[52:55], v[160:163]
  v_exp_f32 v157, v157
  v_mfma_f32_16x16x32_bf16 v[160:163], v[180:183], a[56:59], v[160:163]
  v_exp_f32 v158, v158
  v_mfma_f32_16x16x32_bf16 v[160:163], v[184:187], v[140:143], v[160:163]
  v_exp_f32 v159, v159
  v_mfma_f32_16x16x32_bf16 v[12:15], v[188:191], a[40:43], -4.0
  v_cvt_pk_bf16_f32 v28, v156, v157
  v_add_f32 v6, v156, v6
  v_mfma_f32_16x16x32_bf16 v[12:15], v[192:195], a[44:47], v[12:15]
  v_cvt_pk_bf16_f32 v29, v158, v159
  v_add_f32 v6, v157, v6
  v_mfma_f32_16x16x32_bf16 v[12:15], v[196:199], a[48:51], v[12:15]
  v_add_f32 v6, v158, v6
  v_add_f32 v6, v159, v6
  v_mfma_f32_16x16x32_bf16 v[12:15], v[200:203], a[52:55], v[12:15]
  v_exp_f32 v160, v160
  v_mfma_f32_16x16x32_bf16 v[12:15], v[204:207], a[56:59], v[12:15]
  v_exp_f32 v161, v161
  v_mfma_f32_16x16x32_bf16 v[12:15], v[208:211], v[140:143], v[12:15]
  v_exp_f32 v162, v162
  v_mfma_f32_16x16x32_bf16 v[16:19], v[212:215], a[40:43], -4.0
  v_exp_f32 v163, v163
  v_mfma_f32_16x16x32_bf16 v[16:19], v[216:219], a[44:47], v[16:19]
  v_cvt_pk_bf16_f32 v30, v160, v161
  v_add_f32 v6, v160, v6
  v_mfma_f32_16x16x32_bf16 v[16:19], v[220:223], a[48:51], v[16:19]
  v_cvt_pk_bf16_f32 v31, v162, v163
  v_add_f32 v6, v161, v6
  v_mfma_f32_16x16x32_bf16 v[16:19], v[224:227], a[52:55], v[16:19]
  v_add_f32 v6, v162, v6
  v_add_f32 v6, v163, v6
  v_mfma_f32_16x16x32_bf16 v[16:19], v[228:231], a[56:59], v[16:19]
  v_lshlrev_b32 v120, 16, v96
  v_and_b32 v96, 0xffff0000, v96
  v_mfma_f32_16x16x32_bf16 v[16:19], v[232:235], v[140:143], v[16:19]
  v_lshlrev_b32 v121, 16, v97
  v_and_b32 v97, 0xffff0000, v97
  v_lshlrev_b32 v122, 16, v98
  v_and_b32 v98, 0xffff0000, v98
  v_lshlrev_b32 v123, 16, v99
  v_and_b32 v99, 0xffff0000, v99
  v_lshlrev_b32 v124, 16, v100
  v_and_b32 v100, 0xffff0000, v100
  v_lshlrev_b32 v125, 16, v101
  v_and_b32 v101, 0xffff0000, v101
  v_lshlrev_b32 v126, 16, v102
  v_and_b32 v102, 0xffff0000, v102
  v_lshlrev_b32 v127, 16, v103
  v_and_b32 v103, 0xffff0000, v103
  v_lshlrev_b32 v128, 16, v104
  v_and_b32 v104, 0xffff0000, v104
  v_lshlrev_b32 v129, 16, v105
  v_and_b32 v105, 0xffff0000, v105
  v_lshlrev_b32 v130, 16, v106
  v_and_b32 v106, 0xffff0000, v106
  v_lshlrev_b32 v131, 16, v107
  v_and_b32 v107, 0xffff0000, v107
  v_lshlrev_b32 v132, 16, v108
  v_and_b32 v108, 0xffff0000, v108
  v_lshlrev_b32 v133, 16, v109
  v_and_b32 v109, 0xffff0000, v109
  v_lshlrev_b32 v134, 16, v110
  v_and_b32 v110, 0xffff0000, v110
  v_lshlrev_b32 v135, 16, v111
  v_and_b32 v111, 0xffff0000, v111
  v_lshlrev_b32 v136, 16, v112
  v_and_b32 v112, 0xffff0000, v112
  v_lshlrev_b32 v137, 16, v113
  v_and_b32 v113, 0xffff0000, v113
  v_lshlrev_b32 v138, 16, v114
  v_and_b32 v114, 0xffff0000, v114
  v_lshlrev_b32 v139, 16, v115
  v_and_b32 v115, 0xffff0000, v115
  v_exp_f32 v12, v12
  v_exp_f32 v13, v13
  v_exp_f32 v14, v14
  v_exp_f32 v15, v15
  v_exp_f32 v16, v16
  v_exp_f32 v17, v17
  v_exp_f32 v18, v18
  v_exp_f32 v19, v19
  v_pk_mul_f32 v[116:117], v[116:117], s[52:53]
  v_pk_mul_f32 v[118:119], v[118:119], s[52:53]
  v_pk_mul_f32 v[120:121], v[120:121], s[52:53]
  v_pk_mul_f32 v[122:123], v[122:123], s[52:53]
  v_pk_mul_f32 v[124:125], v[124:125], s[52:53]
  v_pk_mul_f32 v[126:127], v[126:127], s[52:53]
  v_pk_mul_f32 v[128:129], v[128:129], s[52:53]
  v_pk_mul_f32 v[130:131], v[130:131], s[52:53]
  v_pk_mul_f32 v[132:133], v[132:133], s[52:53]
  v_pk_mul_f32 v[134:135], v[134:135], s[52:53]
  v_pk_mul_f32 v[136:137], v[136:137], s[52:53]
  v_pk_mul_f32 v[138:139], v[138:139], s[52:53]
  v_pk_mul_f32 v[92:93], v[92:93], s[52:53]
  v_pk_mul_f32 v[94:95], v[94:95], s[52:53]
  v_pk_mul_f32 v[96:97], v[96:97], s[52:53]
  v_pk_mul_f32 v[98:99], v[98:99], s[52:53]
  v_pk_mul_f32 v[100:101], v[100:101], s[52:53]
  v_pk_mul_f32 v[102:103], v[102:103], s[52:53]
  v_pk_mul_f32 v[104:105], v[104:105], s[52:53]
  v_pk_mul_f32 v[106:107], v[106:107], s[52:53]
  v_pk_mul_f32 v[108:109], v[108:109], s[52:53]
  v_pk_mul_f32 v[110:111], v[110:111], s[52:53]
  v_pk_mul_f32 v[112:113], v[112:113], s[52:53]
  v_pk_mul_f32 v[114:115], v[114:115], s[52:53]
  v_cvt_pk_bf16_f32 v52, v12, v13
  v_add_f32 v6, v12, v6
  v_cvt_pk_bf16_f32 v53, v14, v15
  v_add_f32 v6, v13, v6
  v_add_f32 v6, v14, v6
  v_add_f32 v6, v15, v6
  v_cvt_pk_bf16_f32 v54, v16, v17
  v_add_f32 v6, v16, v6
  v_cvt_pk_bf16_f32 v55, v18, v19
  v_add_f32 v6, v17, v6
  v_add_f32 v6, v18, v6
  v_add_f32 v6, v19, v6
  v_cvt_pk_bf16_f32 v92, v116, v92
  v_cvt_pk_bf16_f32 v93, v117, v93
  v_cvt_pk_bf16_f32 v94, v118, v94
  v_cvt_pk_bf16_f32 v95, v119, v95
  v_accvgpr_write_b32 a60, v92
  v_accvgpr_write_b32 a61, v93
  v_accvgpr_write_b32 a62, v94
  v_accvgpr_write_b32 a63, v95
  v_cvt_pk_bf16_f32 v96, v120, v96
  v_cvt_pk_bf16_f32 v97, v121, v97
  v_cvt_pk_bf16_f32 v98, v122, v98
  v_cvt_pk_bf16_f32 v99, v123, v99
  v_accvgpr_write_b32 a64, v96
  v_accvgpr_write_b32 a65, v97
  v_accvgpr_write_b32 a66, v98
  v_accvgpr_write_b32 a67, v99
  v_cvt_pk_bf16_f32 v100, v124, v100
  v_cvt_pk_bf16_f32 v101, v125, v101
  v_cvt_pk_bf16_f32 v102, v126, v102
  v_cvt_pk_bf16_f32 v103, v127, v103
  v_accvgpr_write_b32 a68, v100
  v_accvgpr_write_b32 a69, v101
  v_accvgpr_write_b32 a70, v102
  v_accvgpr_write_b32 a71, v103
  v_cvt_pk_bf16_f32 v104, v128, v104
  v_cvt_pk_bf16_f32 v105, v129, v105
  v_cvt_pk_bf16_f32 v106, v130, v106
  v_cvt_pk_bf16_f32 v107, v131, v107
  v_accvgpr_write_b32 a72, v104
  v_accvgpr_write_b32 a73, v105
  v_accvgpr_write_b32 a74, v106
  v_accvgpr_write_b32 a75, v107
  v_cvt_pk_bf16_f32 v108, v132, v108
  v_cvt_pk_bf16_f32 v109, v133, v109
  v_cvt_pk_bf16_f32 v110, v134, v110
  v_cvt_pk_bf16_f32 v111, v135, v111
  v_accvgpr_write_b32 a76, v108
  v_accvgpr_write_b32 a77, v109
  v_accvgpr_write_b32 a78, v110
  v_accvgpr_write_b32 a79, v111
  v_cvt_pk_bf16_f32 v144, v136, v112
  v_cvt_pk_bf16_f32 v145, v137, v113
  v_cvt_pk_bf16_f32 v146, v138, v114
  v_cvt_pk_bf16_f32 v147, v139, v115
  ds_write_b128 v3, v[144:147] offset:3072
  s_waitcnt vmcnt(6)
  v_add_u32 v10, s43, v151
  v_add_u32 v11, s43, v152
  ds_read_b128 v[68:71], v10 offset:0
  ds_read_b128 v[72:75], v11 offset:0
  ds_read_b128 v[76:79], v10 offset:128
  ds_read_b128 v[80:83], v11 offset:128
  ds_read_b128 v[84:87], v10 offset:256
  ds_read_b128 v[88:91], v11 offset:256
  v_mfma_f32_16x16x32_bf16 v[156:159], a[124:127], a[60:63], -4.0
  s_mov_b32 s42, 0
  s_add_u32 m0, s97, 75456
  s_nop 0
  buffer_load_dwordx4 v2, s[20:23], s42 offen offset:0 nt lds
  v_mfma_f32_16x16x32_bf16 v[156:159], a[128:131], a[64:67], v[156:159]
  s_add_u32 m0, s97, 79520
  s_nop 0
  buffer_load_dwordx4 v2, s[20:23], s42 offen offset:128 nt lds
  s_add_u32 m0, s97, 83584
  v_mfma_f32_16x16x32_bf16 v[156:159], a[132:135], a[68:71], v[156:159]
  buffer_load_dwordx4 v2, s[20:23], s42 offen offset:256 nt lds
  v_mfma_f32_16x16x32_bf16 v[156:159], a[136:139], a[72:75], v[156:159]
  v_mfma_f32_16x16x32_bf16 v[156:159], a[140:143], a[76:79], v[156:159]
  s_waitcnt lgkmcnt(5)
  v_lshlrev_b32 v116, 16, v68
  v_and_b32 v68, 0xffff0000, v68
  v_mfma_f32_16x16x32_bf16 v[156:159], a[144:147], v[144:147], v[156:159]
  v_lshlrev_b32 v117, 16, v69
  v_and_b32 v69, 0xffff0000, v69
  v_mfma_f32_16x16x32_bf16 v[160:163], v[164:167], a[60:63], -4.0
  v_lshlrev_b32 v118, 16, v70
  v_and_b32 v70, 0xffff0000, v70
  v_mfma_f32_16x16x32_bf16 v[160:163], v[168:171], a[64:67], v[160:163]
  v_lshlrev_b32 v119, 16, v71
  v_and_b32 v71, 0xffff0000, v71
  v_mfma_f32_16x16x32_bf16 v[160:163], v[172:175], a[68:71], v[160:163]
  v_exp_f32 v156, v156
  v_mfma_f32_16x16x32_bf16 v[160:163], v[176:179], a[72:75], v[160:163]
  v_exp_f32 v157, v157
  v_mfma_f32_16x16x32_bf16 v[160:163], v[180:183], a[76:79], v[160:163]
  v_exp_f32 v158, v158
  v_mfma_f32_16x16x32_bf16 v[160:163], v[184:187], v[144:147], v[160:163]
  v_exp_f32 v159, v159
  v_mfma_f32_16x16x32_bf16 v[12:15], v[188:191], a[60:63], -4.0
  v_cvt_pk_bf16_f32 v32, v156, v157
  v_add_f32 v7, v156, v7
  v_mfma_f32_16x16x32_bf16 v[12:15], v[192:195], a[64:67], v[12:15]
  v_cvt_pk_bf16_f32 v33, v158, v159
  v_add_f32 v7, v157, v7
  v_mfma_f32_16x16x32_bf16 v[12:15], v[196:199], a[68:71], v[12:15]
  v_add_f32 v7, v158, v7
  v_add_f32 v7, v159, v7
  v_mfma_f32_16x16x32_bf16 v[12:15], v[200:203], a[72:75], v[12:15]
  v_exp_f32 v160, v160
  v_mfma_f32_16x16x32_bf16 v[12:15], v[204:207], a[76:79], v[12:15]
  v_exp_f32 v161, v161
  v_mfma_f32_16x16x32_bf16 v[12:15], v[208:211], v[144:147], v[12:15]
  v_exp_f32 v162, v162
  v_mfma_f32_16x16x32_bf16 v[16:19], v[212:215], a[60:63], -4.0
  v_exp_f32 v163, v163
  v_mfma_f32_16x16x32_bf16 v[16:19], v[216:219], a[64:67], v[16:19]
  v_cvt_pk_bf16_f32 v34, v160, v161
  v_add_f32 v7, v160, v7
  v_mfma_f32_16x16x32_bf16 v[16:19], v[220:223], a[68:71], v[16:19]
  s_waitcnt lgkmcnt(1)
  v_cvt_pk_bf16_f32 v35, v162, v163
  v_add_f32 v7, v161, v7
  v_mfma_f32_16x16x32_bf16 v[16:19], v[224:227], a[72:75], v[16:19]
  s_waitcnt lgkmcnt(2)
  v_add_f32 v7, v162, v7
  v_add_f32 v7, v163, v7
  v_mfma_f32_16x16x32_bf16 v[16:19], v[228:231], a[76:79], v[16:19]
  s_waitcnt lgkmcnt(4)
  v_lshlrev_b32 v120, 16, v72
  v_and_b32 v72, 0xffff0000, v72
  v_mfma_f32_16x16x32_bf16 v[16:19], v[232:235], v[144:147], v[16:19]
  s_waitcnt lgkmcnt(0)
  s_waitcnt lgkmcnt(3)
  v_lshlrev_b32 v121, 16, v73
  v_and_b32 v73, 0xffff0000, v73
  v_lshlrev_b32 v122, 16, v74
  v_and_b32 v74, 0xffff0000, v74
  v_lshlrev_b32 v123, 16, v75
  v_and_b32 v75, 0xffff0000, v75
  v_lshlrev_b32 v124, 16, v76
  v_and_b32 v76, 0xffff0000, v76
  v_lshlrev_b32 v125, 16, v77
  v_and_b32 v77, 0xffff0000, v77
  v_lshlrev_b32 v126, 16, v78
  v_and_b32 v78, 0xffff0000, v78
  v_lshlrev_b32 v127, 16, v79
  v_and_b32 v79, 0xffff0000, v79
  v_lshlrev_b32 v128, 16, v80
  v_and_b32 v80, 0xffff0000, v80
  v_lshlrev_b32 v129, 16, v81
  v_and_b32 v81, 0xffff0000, v81
  v_lshlrev_b32 v130, 16, v82
  v_and_b32 v82, 0xffff0000, v82
  v_lshlrev_b32 v131, 16, v83
  v_and_b32 v83, 0xffff0000, v83
  v_lshlrev_b32 v132, 16, v84
  v_and_b32 v84, 0xffff0000, v84
  v_lshlrev_b32 v133, 16, v85
  v_and_b32 v85, 0xffff0000, v85
  v_lshlrev_b32 v134, 16, v86
  v_and_b32 v86, 0xffff0000, v86
  v_lshlrev_b32 v135, 16, v87
  v_and_b32 v87, 0xffff0000, v87
  v_lshlrev_b32 v136, 16, v88
  v_and_b32 v88, 0xffff0000, v88
  v_lshlrev_b32 v137, 16, v89
  v_and_b32 v89, 0xffff0000, v89
  v_lshlrev_b32 v138, 16, v90
  v_and_b32 v90, 0xffff0000, v90
  v_lshlrev_b32 v139, 16, v91
  v_and_b32 v91, 0xffff0000, v91
  v_exp_f32 v12, v12
  v_exp_f32 v13, v13
  v_exp_f32 v14, v14
  v_exp_f32 v15, v15
  v_exp_f32 v16, v16
  v_exp_f32 v17, v17
  v_exp_f32 v18, v18
  v_exp_f32 v19, v19
  v_pk_mul_f32 v[116:117], v[116:117], s[52:53]
  v_pk_mul_f32 v[118:119], v[118:119], s[52:53]
  v_pk_mul_f32 v[120:121], v[120:121], s[52:53]
  v_pk_mul_f32 v[122:123], v[122:123], s[52:53]
  v_pk_mul_f32 v[124:125], v[124:125], s[52:53]
  v_pk_mul_f32 v[126:127], v[126:127], s[52:53]
  v_pk_mul_f32 v[128:129], v[128:129], s[52:53]
  v_pk_mul_f32 v[130:131], v[130:131], s[52:53]
  v_pk_mul_f32 v[132:133], v[132:133], s[52:53]
  v_pk_mul_f32 v[134:135], v[134:135], s[52:53]
  v_pk_mul_f32 v[136:137], v[136:137], s[52:53]
  v_pk_mul_f32 v[138:139], v[138:139], s[52:53]
  v_pk_mul_f32 v[68:69], v[68:69], s[52:53]
  v_pk_mul_f32 v[70:71], v[70:71], s[52:53]
  v_pk_mul_f32 v[72:73], v[72:73], s[52:53]
  v_pk_mul_f32 v[74:75], v[74:75], s[52:53]
  v_pk_mul_f32 v[76:77], v[76:77], s[52:53]
  v_pk_mul_f32 v[78:79], v[78:79], s[52:53]
  v_pk_mul_f32 v[80:81], v[80:81], s[52:53]
  v_pk_mul_f32 v[82:83], v[82:83], s[52:53]
  v_pk_mul_f32 v[84:85], v[84:85], s[52:53]
  v_pk_mul_f32 v[86:87], v[86:87], s[52:53]
  v_pk_mul_f32 v[88:89], v[88:89], s[52:53]
  v_pk_mul_f32 v[90:91], v[90:91], s[52:53]
  v_cvt_pk_bf16_f32 v56, v12, v13
  v_add_f32 v7, v12, v7
  v_cvt_pk_bf16_f32 v57, v14, v15
  v_add_f32 v7, v13, v7
  v_add_f32 v7, v14, v7
  v_add_f32 v7, v15, v7
  v_cvt_pk_bf16_f32 v58, v16, v17
  v_add_f32 v7, v16, v7
  v_cvt_pk_bf16_f32 v59, v18, v19
  v_add_f32 v7, v17, v7
  v_add_f32 v7, v18, v7
  v_add_f32 v7, v19, v7
  v_cvt_pk_bf16_f32 v68, v116, v68
  v_cvt_pk_bf16_f32 v69, v117, v69
  v_cvt_pk_bf16_f32 v70, v118, v70
  v_cvt_pk_bf16_f32 v71, v119, v71
  v_accvgpr_write_b32 a80, v68
  v_accvgpr_write_b32 a81, v69
  v_accvgpr_write_b32 a82, v70
  v_accvgpr_write_b32 a83, v71
  v_cvt_pk_bf16_f32 v72, v120, v72
  v_cvt_pk_bf16_f32 v73, v121, v73
  v_cvt_pk_bf16_f32 v74, v122, v74
  v_cvt_pk_bf16_f32 v75, v123, v75
  v_accvgpr_write_b32 a84, v72
  v_accvgpr_write_b32 a85, v73
  v_accvgpr_write_b32 a86, v74
  v_accvgpr_write_b32 a87, v75
  v_cvt_pk_bf16_f32 v76, v124, v76
  v_cvt_pk_bf16_f32 v77, v125, v77
  v_cvt_pk_bf16_f32 v78, v126, v78
  v_cvt_pk_bf16_f32 v79, v127, v79
  v_accvgpr_write_b32 a88, v76
  v_accvgpr_write_b32 a89, v77
  v_accvgpr_write_b32 a90, v78
  v_accvgpr_write_b32 a91, v79
  v_cvt_pk_bf16_f32 v80, v128, v80
  v_cvt_pk_bf16_f32 v81, v129, v81
  v_cvt_pk_bf16_f32 v82, v130, v82
  v_cvt_pk_bf16_f32 v83, v131, v83
  v_accvgpr_write_b32 a92, v80
  v_accvgpr_write_b32 a93, v81
  v_accvgpr_write_b32 a94, v82
  v_accvgpr_write_b32 a95, v83
  v_cvt_pk_bf16_f32 v84, v132, v84
  v_cvt_pk_bf16_f32 v85, v133, v85
  v_cvt_pk_bf16_f32 v86, v134, v86
  v_cvt_pk_bf16_f32 v87, v135, v87
  v_accvgpr_write_b32 a96, v84
  v_accvgpr_write_b32 a97, v85
  v_accvgpr_write_b32 a98, v86
  v_accvgpr_write_b32 a99, v87
  v_cvt_pk_bf16_f32 v140, v136, v88
  v_cvt_pk_bf16_f32 v141, v137, v89
  v_cvt_pk_bf16_f32 v142, v138, v90
  v_cvt_pk_bf16_f32 v143, v139, v91
  ds_write_b128 v3, v[140:143] offset:4096
  s_waitcnt vmcnt(3)
  v_add_u32 v10, s43, v151
  v_add_u32 v11, s43, v152
  ds_read_b128 v[92:95], v10 offset:6144
  ds_read_b128 v[96:99], v11 offset:6144
  ds_read_b128 v[100:103], v10 offset:6272
  ds_read_b128 v[104:107], v11 offset:6272
  ds_read_b128 v[108:111], v10 offset:6400
  ds_read_b128 v[112:115], v11 offset:6400
  v_mfma_f32_16x16x32_bf16 v[156:159], a[124:127], a[80:83], -4.0
  s_mov_b32 s42, 24576
  s_add_u32 m0, s41, 25152
  s_nop 0
  buffer_load_dwordx4 v2, s[16:19], s42 offen offset:0 nt lds
  v_mfma_f32_16x16x32_bf16 v[156:159], a[128:131], a[84:87], v[156:159]
  s_add_u32 m0, s41, 29216
  s_nop 0
  buffer_load_dwordx4 v2, s[16:19], s42 offen offset:128 nt lds
  s_add_u32 m0, s41, 33280
  v_mfma_f32_16x16x32_bf16 v[156:159], a[132:135], a[88:91], v[156:159]
  buffer_load_dwordx4 v2, s[16:19], s42 offen offset:256 nt lds
  s_mov_b32 s42, 12288
  v_mfma_f32_16x16x32_bf16 v[156:159], a[136:139], a[92:95], v[156:159]
  s_add_u32 m0, s97, 88032
  s_nop 0
  buffer_load_dwordx4 v2, s[20:23], s42 offen offset:0 nt lds
  s_add_u32 m0, s97, 92096
  v_mfma_f32_16x16x32_bf16 v[156:159], a[140:143], a[96:99], v[156:159]
  buffer_load_dwordx4 v2, s[20:23], s42 offen offset:128 nt lds
  s_add_u32 m0, s97, 96160
  v_mfma_f32_16x16x32_bf16 v[156:159], a[144:147], v[140:143], v[156:159]
  s_waitcnt lgkmcnt(5)
  buffer_load_dwordx4 v2, s[20:23], s42 offen offset:256 nt lds
  v_lshlrev_b32 v116, 16, v92
  v_mfma_f32_16x16x32_bf16 v[160:163], v[164:167], a[80:83], -4.0
  v_and_b32 v92, 0xffff0000, v92
  v_lshlrev_b32 v117, 16, v93
  v_mfma_f32_16x16x32_bf16 v[160:163], v[168:171], a[84:87], v[160:163]
  v_and_b32 v93, 0xffff0000, v93
  v_lshlrev_b32 v118, 16, v94
  v_mfma_f32_16x16x32_bf16 v[160:163], v[172:175], a[88:91], v[160:163]
  v_exp_f32 v156, v156
  v_mfma_f32_16x16x32_bf16 v[160:163], v[176:179], a[92:95], v[160:163]
  v_exp_f32 v157, v157
  v_mfma_f32_16x16x32_bf16 v[160:163], v[180:183], a[96:99], v[160:163]
  v_exp_f32 v158, v158
  v_mfma_f32_16x16x32_bf16 v[160:163], v[184:187], v[140:143], v[160:163]
  v_exp_f32 v159, v159
  v_mfma_f32_16x16x32_bf16 v[12:15], v[188:191], a[80:83], -4.0
  v_cvt_pk_bf16_f32 v36, v156, v157
  v_add_f32 v8, v156, v8
  v_mfma_f32_16x16x32_bf16 v[12:15], v[192:195], a[84:87], v[12:15]
  v_cvt_pk_bf16_f32 v37, v158, v159
  v_add_f32 v8, v157, v8
  v_mfma_f32_16x16x32_bf16 v[12:15], v[196:199], a[88:91], v[12:15]
  v_add_f32 v8, v158, v8
  v_add_f32 v8, v159, v8
  v_mfma_f32_16x16x32_bf16 v[12:15], v[200:203], a[92:95], v[12:15]
  v_exp_f32 v160, v160
  v_mfma_f32_16x16x32_bf16 v[12:15], v[204:207], a[96:99], v[12:15]
  v_exp_f32 v161, v161
  v_mfma_f32_16x16x32_bf16 v[12:15], v[208:211], v[140:143], v[12:15]
  v_exp_f32 v162, v162
  v_mfma_f32_16x16x32_bf16 v[16:19], v[212:215], a[80:83], -4.0
  v_exp_f32 v163, v163
  v_mfma_f32_16x16x32_bf16 v[16:19], v[216:219], a[84:87], v[16:19]
  v_cvt_pk_bf16_f32 v38, v160, v161
  v_add_f32 v8, v160, v8
  v_mfma_f32_16x16x32_bf16 v[16:19], v[220:223], a[88:91], v[16:19]
  s_waitcnt lgkmcnt(1)
  v_cvt_pk_bf16_f32 v39, v162, v163
  v_add_f32 v8, v161, v8
  v_mfma_f32_16x16x32_bf16 v[16:19], v[224:227], a[92:95], v[16:19]
  s_waitcnt lgkmcnt(2)
  v_add_f32 v8, v162, v8
  v_add_f32 v8, v163, v8
  v_mfma_f32_16x16x32_bf16 v[16:19], v[228:231], a[96:99], v[16:19]
  s_waitcnt lgkmcnt(3)
  v_and_b32 v94, 0xffff0000, v94
  v_lshlrev_b32 v119, 16, v95
  v_mfma_f32_16x16x32_bf16 v[16:19], v[232:235], v[140:143], v[16:19]
  s_waitcnt lgkmcnt(0)
  s_waitcnt lgkmcnt(4)
  v_and_b32 v95, 0xffff0000, v95
  v_lshlrev_b32 v120, 16, v96
  v_and_b32 v96, 0xffff0000, v96
  v_lshlrev_b32 v121, 16, v97
  v_and_b32 v97, 0xffff0000, v97
  v_lshlrev_b32 v122, 16, v98
  v_and_b32 v98, 0xffff0000, v98
  v_lshlrev_b32 v123, 16, v99
  v_and_b32 v99, 0xffff0000, v99
  v_lshlrev_b32 v124, 16, v100
  v_and_b32 v100, 0xffff0000, v100
  v_lshlrev_b32 v125, 16, v101
  v_and_b32 v101, 0xffff0000, v101
  v_lshlrev_b32 v126, 16, v102
  v_and_b32 v102, 0xffff0000, v102
  v_lshlrev_b32 v127, 16, v103
  v_and_b32 v103, 0xffff0000, v103
  v_lshlrev_b32 v128, 16, v104
  v_and_b32 v104, 0xffff0000, v104
  v_lshlrev_b32 v129, 16, v105
  v_and_b32 v105, 0xffff0000, v105
  v_lshlrev_b32 v130, 16, v106
  v_and_b32 v106, 0xffff0000, v106
  v_lshlrev_b32 v131, 16, v107
  v_and_b32 v107, 0xffff0000, v107
  v_lshlrev_b32 v132, 16, v108
  v_and_b32 v108, 0xffff0000, v108
  v_lshlrev_b32 v133, 16, v109
  v_and_b32 v109, 0xffff0000, v109
  v_lshlrev_b32 v134, 16, v110
  v_and_b32 v110, 0xffff0000, v110
  v_lshlrev_b32 v135, 16, v111
  v_and_b32 v111, 0xffff0000, v111
  v_lshlrev_b32 v136, 16, v112
  v_and_b32 v112, 0xffff0000, v112
  v_lshlrev_b32 v137, 16, v113
  v_and_b32 v113, 0xffff0000, v113
  v_lshlrev_b32 v138, 16, v114
  v_and_b32 v114, 0xffff0000, v114
  v_lshlrev_b32 v139, 16, v115
  v_and_b32 v115, 0xffff0000, v115
  v_exp_f32 v12, v12
  v_exp_f32 v13, v13
  v_exp_f32 v14, v14
  v_exp_f32 v15, v15
  v_exp_f32 v16, v16
  v_exp_f32 v17, v17
  v_exp_f32 v18, v18
  v_exp_f32 v19, v19
  v_pk_mul_f32 v[116:117], v[116:117], s[52:53]
  v_pk_mul_f32 v[118:119], v[118:119], s[52:53]
  v_pk_mul_f32 v[120:121], v[120:121], s[52:53]
  v_pk_mul_f32 v[122:123], v[122:123], s[52:53]
  v_pk_mul_f32 v[124:125], v[124:125], s[52:53]
  v_pk_mul_f32 v[126:127], v[126:127], s[52:53]
  v_pk_mul_f32 v[128:129], v[128:129], s[52:53]
  v_pk_mul_f32 v[130:131], v[130:131], s[52:53]
  v_pk_mul_f32 v[132:133], v[132:133], s[52:53]
  v_pk_mul_f32 v[134:135], v[134:135], s[52:53]
  v_pk_mul_f32 v[136:137], v[136:137], s[52:53]
  v_pk_mul_f32 v[138:139], v[138:139], s[52:53]
  v_pk_mul_f32 v[92:93], v[92:93], s[52:53]
  v_pk_mul_f32 v[94:95], v[94:95], s[52:53]
  v_pk_mul_f32 v[96:97], v[96:97], s[52:53]
  v_pk_mul_f32 v[98:99], v[98:99], s[52:53]
  v_pk_mul_f32 v[100:101], v[100:101], s[52:53]
  v_pk_mul_f32 v[102:103], v[102:103], s[52:53]
  v_pk_mul_f32 v[104:105], v[104:105], s[52:53]
  v_pk_mul_f32 v[106:107], v[106:107], s[52:53]
  v_pk_mul_f32 v[108:109], v[108:109], s[52:53]
  v_pk_mul_f32 v[110:111], v[110:111], s[52:53]
  v_pk_mul_f32 v[112:113], v[112:113], s[52:53]
  v_pk_mul_f32 v[114:115], v[114:115], s[52:53]
  v_cvt_pk_bf16_f32 v60, v12, v13
  v_add_f32 v8, v12, v8
  v_cvt_pk_bf16_f32 v61, v14, v15
  v_add_f32 v8, v13, v8
  v_add_f32 v8, v14, v8
  v_add_f32 v8, v15, v8
  v_cvt_pk_bf16_f32 v62, v16, v17
  v_add_f32 v8, v16, v8
  v_cvt_pk_bf16_f32 v63, v18, v19
  v_add_f32 v8, v17, v8
  v_add_f32 v8, v18, v8
  v_add_f32 v8, v19, v8
  v_cvt_pk_bf16_f32 v92, v116, v92
  v_cvt_pk_bf16_f32 v93, v117, v93
  v_cvt_pk_bf16_f32 v94, v118, v94
  v_cvt_pk_bf16_f32 v95, v119, v95
  v_accvgpr_write_b32 a100, v92
  v_accvgpr_write_b32 a101, v93
  v_accvgpr_write_b32 a102, v94
  v_accvgpr_write_b32 a103, v95
  v_cvt_pk_bf16_f32 v96, v120, v96
  v_cvt_pk_bf16_f32 v97, v121, v97
  v_cvt_pk_bf16_f32 v98, v122, v98
  v_cvt_pk_bf16_f32 v99, v123, v99
  v_accvgpr_write_b32 a104, v96
  v_accvgpr_write_b32 a105, v97
  v_accvgpr_write_b32 a106, v98
  v_accvgpr_write_b32 a107, v99
  v_cvt_pk_bf16_f32 v100, v124, v100
  v_cvt_pk_bf16_f32 v101, v125, v101
  v_cvt_pk_bf16_f32 v102, v126, v102
  v_cvt_pk_bf16_f32 v103, v127, v103
  v_accvgpr_write_b32 a108, v100
  v_accvgpr_write_b32 a109, v101
  v_accvgpr_write_b32 a110, v102
  v_accvgpr_write_b32 a111, v103
  v_cvt_pk_bf16_f32 v104, v128, v104
  v_cvt_pk_bf16_f32 v105, v129, v105
  v_cvt_pk_bf16_f32 v106, v130, v106
  v_cvt_pk_bf16_f32 v107, v131, v107
  v_accvgpr_write_b32 a112, v104
  v_accvgpr_write_b32 a113, v105
  v_accvgpr_write_b32 a114, v106
  v_accvgpr_write_b32 a115, v107
  v_cvt_pk_bf16_f32 v108, v132, v108
  v_cvt_pk_bf16_f32 v109, v133, v109
  v_cvt_pk_bf16_f32 v110, v134, v110
  v_cvt_pk_bf16_f32 v111, v135, v111
  v_accvgpr_write_b32 a116, v108
  v_accvgpr_write_b32 a117, v109
  v_accvgpr_write_b32 a118, v110
  v_accvgpr_write_b32 a119, v111
  v_cvt_pk_bf16_f32 v144, v136, v112
  v_cvt_pk_bf16_f32 v145, v137, v113
  v_cvt_pk_bf16_f32 v146, v138, v114
  v_cvt_pk_bf16_f32 v147, v139, v115
  ds_write_b128 v3, v[144:147] offset:5120
  v_add_u32 v0, 25152, v0
  v_add_u32 v1, 12576, v1
  s_mov_b32 s36, 25152
  s_add_u32 s35, s41, 50304
  s_add_u32 s54, s41, 62880
  s_mov_b32 s33, 49152
  s_mov_b32 s34, 36864
  s_sub_u32 s96, s35, s3
  s_waitcnt vmcnt(6) lgkmcnt(0)
  s_barrier
  v_mfma_f32_16x16x32_bf16 v[156:159], a[124:127], a[100:103], -4.0
  v_mfma_f32_16x16x32_bf16 v[156:159], a[128:131], a[104:107], v[156:159]
  v_mfma_f32_16x16x32_bf16 v[156:159], a[132:135], a[108:111], v[156:159]
  v_mfma_f32_16x16x32_bf16 v[156:159], a[136:139], a[112:115], v[156:159]
  v_mfma_f32_16x16x32_bf16 v[156:159], a[140:143], a[116:119], v[156:159]
  v_mfma_f32_16x16x32_bf16 v[156:159], a[144:147], v[144:147], v[156:159]
  v_mfma_f32_16x16x32_bf16 v[160:163], v[164:167], a[100:103], -4.0
  ds_read_b64_tr_b16 a[124:125], v1 offset:0
  v_mfma_f32_16x16x32_bf16 v[160:163], v[168:171], a[104:107], v[160:163]
  ds_read_b64_tr_b16 a[126:127], v1 offset:512
  v_mfma_f32_16x16x32_bf16 v[160:163], v[172:175], a[108:111], v[160:163]
  s_nop 2
  v_exp_f32 v156, v156
  v_mfma_f32_16x16x32_bf16 v[160:163], v[176:179], a[112:115], v[160:163]
  v_exp_f32 v157, v157
  v_mfma_f32_16x16x32_bf16 v[160:163], v[180:183], a[116:119], v[160:163]
  v_exp_f32 v158, v158
  v_mfma_f32_16x16x32_bf16 v[160:163], v[184:187], v[144:147], v[160:163]
  v_exp_f32 v159, v159
  v_mfma_f32_16x16x32_bf16 v[12:15], v[188:191], a[100:103], -4.0
  v_cvt_pk_bf16_f32 v40, v156, v157
  v_add_f32 v9, v156, v9
  v_mfma_f32_16x16x32_bf16 v[12:15], v[192:195], a[104:107], v[12:15]
  v_cvt_pk_bf16_f32 v41, v158, v159
  v_add_f32 v9, v157, v9
  v_mfma_f32_16x16x32_bf16 v[12:15], v[196:199], a[108:111], v[12:15]
  v_add_f32 v9, v158, v9
  v_add_f32 v9, v159, v9
  v_mfma_f32_16x16x32_bf16 v[12:15], v[200:203], a[112:115], v[12:15]
  ds_read_b64_tr_b16 a[128:129], v1 offset:16
  v_mfma_f32_16x16x32_bf16 v[12:15], v[204:207], a[116:119], v[12:15]
  ds_read_b64_tr_b16 a[130:131], v1 offset:528
  v_mfma_f32_16x16x32_bf16 v[12:15], v[208:211], v[144:147], v[12:15]
  v_exp_f32 v160, v160
  v_mfma_f32_16x16x32_bf16 v[16:19], v[212:215], a[100:103], -4.0
  v_exp_f32 v161, v161
  v_mfma_f32_16x16x32_bf16 v[16:19], v[216:219], a[104:107], v[16:19]
  v_exp_f32 v162, v162
  v_mfma_f32_16x16x32_bf16 v[16:19], v[220:223], a[108:111], v[16:19]
  v_exp_f32 v163, v163
  v_mfma_f32_16x16x32_bf16 v[16:19], v[224:227], a[112:115], v[16:19]
  v_cvt_pk_bf16_f32 v42, v160, v161
  v_add_f32 v9, v160, v9
  v_mfma_f32_16x16x32_bf16 v[16:19], v[228:231], a[116:119], v[16:19]
  v_cvt_pk_bf16_f32 v43, v162, v163
  v_add_f32 v9, v161, v9
  v_mfma_f32_16x16x32_bf16 v[16:19], v[232:235], v[144:147], v[16:19]
  s_waitcnt lgkmcnt(2)
  v_add_f32 v9, v162, v9
  v_add_f32 v9, v163, v9
  v_mfma_f32_16x16x32_bf16 v[68:71], v[20:23], a[124:127], 0
  ds_read_b64_tr_b16 a[132:133], v1 offset:32
  v_mfma_f32_16x16x32_bf16 v[116:119], v[24:27], a[124:127], 0
  ds_read_b64_tr_b16 a[134:135], v1 offset:544
  v_mfma_f32_16x16x32_bf16 v[164:167], v[28:31], a[124:127], 0
  s_mov_b32 s42, 36864
  s_add_u32 m0, s41, 37728
  ds_read_b64_tr_b16 a[136:137], v1 offset:48
  v_mfma_f32_16x16x32_bf16 v[212:215], v[32:35], a[124:127], 0
  ds_read_b64_tr_b16 a[138:139], v1 offset:560
  v_mfma_f32_16x16x32_bf16 a[160:163], v[36:39], a[124:127], 0
  buffer_load_dwordx4 v2, s[16:19], s42 offen offset:0 nt lds
  s_add_u32 m0, s41, 41792
  v_mfma_f32_16x16x32_bf16 a[208:211], v[40:43], a[124:127], 0
  s_waitcnt lgkmcnt(4)
  ds_read_b64_tr_b16 a[124:125], v1 offset:4192
  v_mfma_f32_16x16x32_bf16 v[72:75], v[20:23], a[128:131], 0
  ds_read_b64_tr_b16 a[126:127], v1 offset:4704
  v_mfma_f32_16x16x32_bf16 v[120:123], v[24:27], a[128:131], 0
  buffer_load_dwordx4 v2, s[16:19], s42 offen offset:128 nt lds
  s_add_u32 m0, s41, 45856
  v_mfma_f32_16x16x32_bf16 v[168:171], v[28:31], a[128:131], 0
  buffer_load_dwordx4 v2, s[16:19], s42 offen offset:256 nt lds
  s_mov_b32 s42, 24576
  v_mfma_f32_16x16x32_bf16 v[216:219], v[32:35], a[128:131], 0
  s_add_u32 m0, s97, 100608
  s_nop 0
  buffer_load_dwordx4 v2, s[20:23], s42 offen offset:0 nt lds
  s_add_u32 m0, s97, 104672
  v_mfma_f32_16x16x32_bf16 a[164:167], v[36:39], a[128:131], 0
  buffer_load_dwordx4 v2, s[20:23], s42 offen offset:128 nt lds
  s_add_u32 m0, s97, 108736
  v_mfma_f32_16x16x32_bf16 a[212:215], v[40:43], a[128:131], 0
  s_waitcnt lgkmcnt(4)
  ds_read_b64_tr_b16 a[128:129], v1 offset:4208
  v_mfma_f32_16x16x32_bf16 v[76:79], v[20:23], a[132:135], 0
  ds_read_b64_tr_b16 a[130:131], v1 offset:4720
  v_mfma_f32_16x16x32_bf16 v[124:127], v[24:27], a[132:135], 0
  buffer_load_dwordx4 v2, s[20:23], s42 offen offset:256 nt lds
  v_mfma_f32_16x16x32_bf16 v[172:175], v[28:31], a[132:135], 0
  v_exp_f32 v12, v12
  v_mfma_f32_16x16x32_bf16 v[220:223], v[32:35], a[132:135], 0
  v_exp_f32 v13, v13
  v_mfma_f32_16x16x32_bf16 a[168:171], v[36:39], a[132:135], 0
  v_exp_f32 v14, v14
  v_mfma_f32_16x16x32_bf16 a[216:219], v[40:43], a[132:135], 0
  s_waitcnt lgkmcnt(4)
  ds_read_b64_tr_b16 a[132:133], v1 offset:4224
  v_mfma_f32_16x16x32_bf16 v[80:83], v[20:23], a[136:139], 0
  ds_read_b64_tr_b16 a[134:135], v1 offset:4736
  v_mfma_f32_16x16x32_bf16 v[128:131], v[24:27], a[136:139], 0
  v_exp_f32 v15, v15
  v_mfma_f32_16x16x32_bf16 v[176:179], v[28:31], a[136:139], 0
  v_cvt_pk_bf16_f32 v64, v12, v13
  v_add_f32 v9, v12, v9
  v_mfma_f32_16x16x32_bf16 v[224:227], v[32:35], a[136:139], 0
  v_cvt_pk_bf16_f32 v65, v14, v15
  v_add_f32 v9, v13, v9
  v_mfma_f32_16x16x32_bf16 a[172:175], v[36:39], a[136:139], 0
  v_add_f32 v9, v14, v9
  v_add_f32 v9, v15, v9
  v_mfma_f32_16x16x32_bf16 a[220:223], v[40:43], a[136:139], 0
  s_waitcnt lgkmcnt(4)
  ds_read_b64_tr_b16 a[136:137], v1 offset:4240
  v_mfma_f32_16x16x32_bf16 v[84:87], v[20:23], a[124:127], 0
  ds_read_b64_tr_b16 a[138:139], v1 offset:4752
  v_mfma_f32_16x16x32_bf16 v[132:135], v[24:27], a[124:127], 0
  ds_read_b64_tr_b16 a[148:149], v1 offset:8384
  v_mfma_f32_16x16x32_bf16 v[180:183], v[28:31], a[124:127], 0
  ds_read_b64_tr_b16 a[150:151], v1 offset:8896
  v_mfma_f32_16x16x32_bf16 v[228:231], v[32:35], a[124:127], 0
  ds_read_b64_tr_b16 a[152:153], v1 offset:8400
  v_mfma_f32_16x16x32_bf16 a[176:179], v[36:39], a[124:127], 0
  ds_read_b64_tr_b16 a[154:155], v1 offset:8912
  v_mfma_f32_16x16x32_bf16 a[224:227], v[40:43], a[124:127], 0
  s_waitcnt lgkmcnt(8)
  v_exp_f32 v16, v16
  v_mfma_f32_16x16x32_bf16 v[88:91], v[20:23], a[128:131], 0
  v_exp_f32 v17, v17
  v_mfma_f32_16x16x32_bf16 v[136:139], v[24:27], a[128:131], 0
  v_mfma_f32_16x16x32_bf16 v[184:187], v[28:31], a[128:131], 0
  v_mfma_f32_16x16x32_bf16 v[232:235], v[32:35], a[128:131], 0
  v_mfma_f32_16x16x32_bf16 a[180:183], v[36:39], a[128:131], 0
  v_mfma_f32_16x16x32_bf16 a[228:231], v[40:43], a[128:131], 0
  s_waitcnt lgkmcnt(6)
  v_mfma_f32_16x16x32_bf16 v[92:95], v[20:23], a[132:135], 0
  v_mfma_f32_16x16x32_bf16 v[140:143], v[24:27], a[132:135], 0
  v_mfma_f32_16x16x32_bf16 v[188:191], v[28:31], a[132:135], 0
  v_mfma_f32_16x16x32_bf16 v[236:239], v[32:35], a[132:135], 0
  v_mfma_f32_16x16x32_bf16 a[184:187], v[36:39], a[132:135], 0
  v_mfma_f32_16x16x32_bf16 a[232:235], v[40:43], a[132:135], 0
  s_waitcnt lgkmcnt(4)
  v_mfma_f32_16x16x32_bf16 v[96:99], v[20:23], a[136:139], 0
  v_mfma_f32_16x16x32_bf16 v[144:147], v[24:27], a[136:139], 0
  v_mfma_f32_16x16x32_bf16 v[192:195], v[28:31], a[136:139], 0
  v_mfma_f32_16x16x32_bf16 v[240:243], v[32:35], a[136:139], 0
  v_mfma_f32_16x16x32_bf16 a[188:191], v[36:39], a[136:139], 0
  v_mfma_f32_16x16x32_bf16 a[236:239], v[40:43], a[136:139], 0
  s_waitcnt lgkmcnt(2)
  s_waitcnt vmcnt(6)
  v_mfma_f32_16x16x32_bf16 v[100:103], v[20:23], a[148:151], 0
  s_barrier
  v_mfma_f32_16x16x32_bf16 v[148:151], v[24:27], a[148:151], 0
  ds_read_b128 a[124:127], v0 offset:0
  v_mfma_f32_16x16x32_bf16 v[196:199], v[28:31], a[148:151], 0
  ds_read_b128 a[128:131], v0 offset:64
  v_mfma_f32_16x16x32_bf16 v[244:247], v[32:35], a[148:151], 0
  ds_read_b128 a[132:135], v0 offset:4192
  v_mfma_f32_16x16x32_bf16 a[192:195], v[36:39], a[148:151], 0
  ds_read_b128 a[136:139], v0 offset:4256
  v_mfma_f32_16x16x32_bf16 a[240:243], v[40:43], a[148:151], 0
  s_waitcnt lgkmcnt(4)
  ds_read_b64_tr_b16 a[148:149], v1 offset:8416
  v_mfma_f32_16x16x32_bf16 v[104:107], v[20:23], a[152:155], 0
  ds_read_b64_tr_b16 a[150:151], v1 offset:8928
  v_mfma_f32_16x16x32_bf16 v[152:155], v[24:27], a[152:155], 0
  ds_read_b128 a[140:143], v0 offset:8384
  v_mfma_f32_16x16x32_bf16 v[200:203], v[28:31], a[152:155], 0
  ds_read_b128 a[144:147], v0 offset:8448
  v_mfma_f32_16x16x32_bf16 v[248:251], v[32:35], a[152:155], 0
  ds_read_b128 a[120:123], v3 offset:0
  v_mfma_f32_16x16x32_bf16 a[196:199], v[36:39], a[152:155], 0
  v_mfma_f32_16x16x32_bf16 a[244:247], v[40:43], a[152:155], 0
  s_waitcnt lgkmcnt(3)
  ds_read_b64_tr_b16 a[152:153], v1 offset:8432
  v_mfma_f32_16x16x32_bf16 v[108:111], v[20:23], a[148:151], 0
  ds_read_b64_tr_b16 a[154:155], v1 offset:8944
  v_mfma_f32_16x16x32_bf16 v[156:159], v[24:27], a[148:151], 0
  v_mfma_f32_16x16x32_bf16 v[204:207], v[28:31], a[148:151], 0
  v_mfma_f32_16x16x32_bf16 v[252:255], v[32:35], a[148:151], 0
  v_mfma_f32_16x16x32_bf16 a[200:203], v[36:39], a[148:151], 0
  v_mfma_f32_16x16x32_bf16 a[248:251], v[40:43], a[148:151], 0
  s_waitcnt lgkmcnt(0)
  ds_read_b64_tr_b16 a[148:149], v1 offset:12576
  v_mfma_f32_16x16x32_bf16 v[112:115], v[20:23], a[152:155], 0
  ds_read_b64_tr_b16 a[150:151], v1 offset:13088
  v_add_u32 v1, 12576, v1
  v_mfma_f32_16x16x32_bf16 v[160:163], v[24:27], a[152:155], 0
  v_mfma_f32_16x16x32_bf16 v[208:211], v[28:31], a[152:155], 0
  v_mfma_f32_16x16x32_bf16 a[156:159], v[32:35], a[152:155], 0
  v_mfma_f32_16x16x32_bf16 a[204:207], v[36:39], a[152:155], 0
  v_mfma_f32_16x16x32_bf16 a[252:255], v[40:43], a[152:155], 0
  v_mfma_f32_16x16x32_bf16 v[12:15], a[124:127], a[0:3], -4.0
  v_exp_f32 v18, v18
  v_mfma_f32_16x16x32_bf16 v[12:15], a[128:131], a[4:7], v[12:15]
  v_exp_f32 v19, v19
  v_mfma_f32_16x16x32_bf16 v[12:15], a[132:135], a[8:11], v[12:15]
  ds_read_b64_tr_b16 a[152:153], v1 offset:16
  v_add_f32 v9, v16, v9
  v_mfma_f32_16x16x32_bf16 v[12:15], a[136:139], a[12:15], v[12:15]
  ds_read_b64_tr_b16 a[154:155], v1 offset:528
  v_add_f32 v9, v17, v9
  v_mfma_f32_16x16x32_bf16 v[12:15], a[140:143], a[16:19], v[12:15]
  v_cvt_pk_bf16_f32 v66, v16, v17
  v_add_f32 v9, v18, v9
  v_mfma_f32_16x16x32_bf16 v[12:15], a[144:147], a[120:123], v[12:15]
  s_waitcnt lgkmcnt(2)
  ds_read_b128 a[120:123], v3 offset:1024
  v_add_f32 v9, v19, v9
  v_mfma_f32_16x16x32_bf16 v[68:71], v[44:47], a[148:151], v[68:71]
  v_cvt_pk_bf16_f32 v67, v18, v19
  v_mfma_f32_16x16x32_bf16 v[116:119], v[48:51], a[148:151], v[116:119]
.p2align 6
L_top:
  v_mfma_f32_16x16x32_bf16 v[164:167], v[52:55], a[148:151], v[164:167]
  v_mfma_f32_16x16x32_bf16 v[212:215], v[56:59], a[148:151], v[212:215]
  v_exp_f32 v12, v12
  v_mfma_f32_16x16x32_bf16 a[160:163], v[60:63], a[148:151], a[160:163]
  v_exp_f32 v13, v13
  v_mfma_f32_16x16x32_bf16 a[208:211], v[64:67], a[148:151], a[208:211]
  v_exp_f32 v14, v14
  v_mfma_f32_16x16x32_bf16 v[16:19], a[124:127], a[20:23], -4.0
  v_exp_f32 v15, v15
  v_mfma_f32_16x16x32_bf16 v[16:19], a[128:131], a[24:27], v[16:19]
  ds_read_b64_tr_b16 a[148:149], v1 offset:32
  v_add_f32 v4, v12, v4
  v_mfma_f32_16x16x32_bf16 v[16:19], a[132:135], a[28:31], v[16:19]
  ds_read_b64_tr_b16 a[150:151], v1 offset:544
  v_add_f32 v4, v13, v4
  v_mfma_f32_16x16x32_bf16 v[16:19], a[136:139], a[32:35], v[16:19]
  v_cvt_pk_bf16_f32 v20, v12, v13
  v_mfma_f32_16x16x32_bf16 v[16:19], a[140:143], a[36:39], v[16:19]
  s_waitcnt lgkmcnt(2)
  v_add_f32 v4, v14, v4
  v_mfma_f32_16x16x32_bf16 v[16:19], a[144:147], a[120:123], v[16:19]
  s_add_u32 m0, s35, 0
  ds_read_b128 a[120:123], v3 offset:2048
  v_add_f32 v4, v15, v4
  v_mfma_f32_16x16x32_bf16 v[72:75], v[44:47], a[152:155], v[72:75]
  buffer_load_dwordx4 v2, s[16:19], s33 offen offset:0 nt lds
  v_mfma_f32_16x16x32_bf16 v[120:123], v[48:51], a[152:155], v[120:123]
  v_cvt_pk_bf16_f32 v21, v14, v15
  v_mfma_f32_16x16x32_bf16 v[168:171], v[52:55], a[152:155], v[168:171]
  v_mfma_f32_16x16x32_bf16 v[216:219], v[56:59], a[152:155], v[216:219]
  v_exp_f32 v16, v16
  v_mfma_f32_16x16x32_bf16 a[164:167], v[60:63], a[152:155], a[164:167]
  v_exp_f32 v17, v17
  v_mfma_f32_16x16x32_bf16 a[212:215], v[64:67], a[152:155], a[212:215]
  v_exp_f32 v18, v18
  v_mfma_f32_16x16x32_bf16 v[12:15], a[124:127], a[40:43], -4.0
  v_exp_f32 v19, v19
  v_mfma_f32_16x16x32_bf16 v[12:15], a[128:131], a[44:47], v[12:15]
  ds_read_b64_tr_b16 a[152:153], v1 offset:48
  v_add_f32 v5, v16, v5
  v_mfma_f32_16x16x32_bf16 v[12:15], a[132:135], a[48:51], v[12:15]
  ds_read_b64_tr_b16 a[154:155], v1 offset:560
  v_add_f32 v5, v17, v5
  v_mfma_f32_16x16x32_bf16 v[12:15], a[136:139], a[52:55], v[12:15]
  v_cvt_pk_bf16_f32 v24, v16, v17
  v_mfma_f32_16x16x32_bf16 v[12:15], a[140:143], a[56:59], v[12:15]
  s_waitcnt lgkmcnt(2)
  v_add_f32 v5, v18, v5
  v_mfma_f32_16x16x32_bf16 v[12:15], a[144:147], a[120:123], v[12:15]
  s_add_u32 m0, s35, 4064
  ds_read_b128 a[120:123], v3 offset:3072
  v_add_f32 v5, v19, v5
  v_mfma_f32_16x16x32_bf16 v[76:79], v[44:47], a[148:151], v[76:79]
  buffer_load_dwordx4 v2, s[16:19], s33 offen offset:128 nt lds
  v_mfma_f32_16x16x32_bf16 v[124:127], v[48:51], a[148:151], v[124:127]
  v_cvt_pk_bf16_f32 v25, v18, v19
  v_mfma_f32_16x16x32_bf16 v[172:175], v[52:55], a[148:151], v[172:175]
  v_mfma_f32_16x16x32_bf16 v[220:223], v[56:59], a[148:151], v[220:223]
  v_exp_f32 v12, v12
  v_mfma_f32_16x16x32_bf16 a[168:171], v[60:63], a[148:151], a[168:171]
  v_exp_f32 v13, v13
  v_mfma_f32_16x16x32_bf16 a[216:219], v[64:67], a[148:151], a[216:219]
  v_exp_f32 v14, v14
  v_mfma_f32_16x16x32_bf16 v[16:19], a[124:127], a[60:63], -4.0
  v_exp_f32 v15, v15
  v_mfma_f32_16x16x32_bf16 v[16:19], a[128:131], a[64:67], v[16:19]
  ds_read_b64_tr_b16 a[148:149], v1 offset:4192
  v_add_f32 v6, v12, v6
  v_mfma_f32_16x16x32_bf16 v[16:19], a[132:135], a[68:71], v[16:19]
  ds_read_b64_tr_b16 a[150:151], v1 offset:4704
  v_add_f32 v6, v13, v6
  v_mfma_f32_16x16x32_bf16 v[16:19], a[136:139], a[72:75], v[16:19]
  v_cvt_pk_bf16_f32 v28, v12, v13
  v_mfma_f32_16x16x32_bf16 v[16:19], a[140:143], a[76:79], v[16:19]
  s_waitcnt lgkmcnt(2)
  v_add_f32 v6, v14, v6
  v_mfma_f32_16x16x32_bf16 v[16:19], a[144:147], a[120:123], v[16:19]
  s_add_u32 m0, s35, 8128
  ds_read_b128 a[120:123], v3 offset:4096
  v_add_f32 v6, v15, v6
  v_mfma_f32_16x16x32_bf16 v[80:83], v[44:47], a[152:155], v[80:83]
  buffer_load_dwordx4 v2, s[16:19], s33 offen offset:256 nt lds
  v_mfma_f32_16x16x32_bf16 v[128:131], v[48:51], a[152:155], v[128:131]
  v_cvt_pk_bf16_f32 v29, v14, v15
  v_mfma_f32_16x16x32_bf16 v[176:179], v[52:55], a[152:155], v[176:179]
  v_mfma_f32_16x16x32_bf16 v[224:227], v[56:59], a[152:155], v[224:227]
  v_exp_f32 v16, v16
  v_mfma_f32_16x16x32_bf16 a[172:175], v[60:63], a[152:155], a[172:175]
  v_exp_f32 v17, v17
  v_mfma_f32_16x16x32_bf16 a[220:223], v[64:67], a[152:155], a[220:223]
  v_exp_f32 v18, v18
  v_mfma_f32_16x16x32_bf16 v[12:15], a[124:127], a[80:83], -4.0
  v_exp_f32 v19, v19
  v_mfma_f32_16x16x32_bf16 v[12:15], a[128:131], a[84:87], v[12:15]
  ds_read_b64_tr_b16 a[152:153], v1 offset:4208
  v_add_f32 v7, v16, v7
  v_mfma_f32_16x16x32_bf16 v[12:15], a[132:135], a[88:91], v[12:15]
  ds_read_b64_tr_b16 a[154:155], v1 offset:4720
  v_add_f32 v7, v17, v7
  v_mfma_f32_16x16x32_bf16 v[12:15], a[136:139], a[92:95], v[12:15]
  v_cvt_pk_bf16_f32 v32, v16, v17
  v_mfma_f32_16x16x32_bf16 v[12:15], a[140:143], a[96:99], v[12:15]
  s_waitcnt lgkmcnt(2)
  v_add_f32 v7, v18, v7
  v_mfma_f32_16x16x32_bf16 v[12:15], a[144:147], a[120:123], v[12:15]
  s_add_u32 m0, s96, 62880
  ds_read_b128 a[120:123], v3 offset:5120
  v_add_f32 v7, v19, v7
  v_mfma_f32_16x16x32_bf16 v[84:87], v[44:47], a[148:151], v[84:87]
  buffer_load_dwordx4 v2, s[20:23], s34 offen offset:0 nt lds
  v_mfma_f32_16x16x32_bf16 v[132:135], v[48:51], a[148:151], v[132:135]
  v_cvt_pk_bf16_f32 v33, v18, v19
  v_mfma_f32_16x16x32_bf16 v[180:183], v[52:55], a[148:151], v[180:183]
  v_mfma_f32_16x16x32_bf16 v[228:231], v[56:59], a[148:151], v[228:231]
  v_exp_f32 v12, v12
  v_mfma_f32_16x16x32_bf16 a[176:179], v[60:63], a[148:151], a[176:179]
  v_exp_f32 v13, v13
  v_mfma_f32_16x16x32_bf16 a[224:227], v[64:67], a[148:151], a[224:227]
  v_exp_f32 v14, v14
  v_mfma_f32_16x16x32_bf16 v[16:19], a[124:127], a[100:103], -4.0
  v_exp_f32 v15, v15
  v_mfma_f32_16x16x32_bf16 v[16:19], a[128:131], a[104:107], v[16:19]
  ds_read_b128 a[124:127], v0 offset:512
  v_add_f32 v8, v12, v8
  v_mfma_f32_16x16x32_bf16 v[16:19], a[132:135], a[108:111], v[16:19]
  ds_read_b128 a[128:131], v0 offset:576
  v_add_f32 v8, v13, v8
  v_mfma_f32_16x16x32_bf16 v[16:19], a[136:139], a[112:115], v[16:19]
  ds_read_b128 a[132:135], v0 offset:4704
  v_cvt_pk_bf16_f32 v36, v12, v13
  v_mfma_f32_16x16x32_bf16 v[16:19], a[140:143], a[116:119], v[16:19]
  s_waitcnt lgkmcnt(3)
  ds_read_b128 a[136:139], v0 offset:4768
  v_add_f32 v8, v14, v8
  v_mfma_f32_16x16x32_bf16 v[16:19], a[144:147], a[120:123], v[16:19]
  ds_read_b128 a[140:143], v0 offset:8896
  v_add_f32 v8, v15, v8
  v_mfma_f32_16x16x32_bf16 v[88:91], v[44:47], a[152:155], v[88:91]
  ds_read_b128 a[144:147], v0 offset:8960
  v_cvt_pk_bf16_f32 v37, v14, v15
  v_mfma_f32_16x16x32_bf16 v[136:139], v[48:51], a[152:155], v[136:139]
  ds_read_b128 a[120:123], v3 offset:0
  v_mfma_f32_16x16x32_bf16 v[184:187], v[52:55], a[152:155], v[184:187]
  ds_read_b64_tr_b16 a[148:149], v1 offset:4224
  v_mfma_f32_16x16x32_bf16 v[232:235], v[56:59], a[152:155], v[232:235]
  ds_read_b64_tr_b16 a[150:151], v1 offset:4736
  v_mfma_f32_16x16x32_bf16 a[180:183], v[60:63], a[152:155], a[180:183]
  v_exp_f32 v16, v16
  v_mfma_f32_16x16x32_bf16 a[228:231], v[64:67], a[152:155], a[228:231]
  s_waitcnt lgkmcnt(8)
  v_exp_f32 v17, v17
  v_mfma_f32_16x16x32_bf16 v[12:15], a[124:127], a[0:3], -4.0
  s_waitcnt lgkmcnt(7)
  v_exp_f32 v18, v18
  v_mfma_f32_16x16x32_bf16 v[12:15], a[128:131], a[4:7], v[12:15]
  s_waitcnt lgkmcnt(6)
  v_exp_f32 v19, v19
  v_mfma_f32_16x16x32_bf16 v[12:15], a[132:135], a[8:11], v[12:15]
  s_waitcnt lgkmcnt(5)
  ds_read_b64_tr_b16 a[152:153], v1 offset:4240
  v_add_f32 v9, v16, v9
  v_mfma_f32_16x16x32_bf16 v[12:15], a[136:139], a[12:15], v[12:15]
  s_waitcnt lgkmcnt(5)
  ds_read_b64_tr_b16 a[154:155], v1 offset:4752
  v_add_f32 v9, v17, v9
  v_mfma_f32_16x16x32_bf16 v[12:15], a[140:143], a[16:19], v[12:15]
  s_waitcnt lgkmcnt(4)
  v_cvt_pk_bf16_f32 v40, v16, v17
  v_add_f32 v9, v18, v9
  v_mfma_f32_16x16x32_bf16 v[12:15], a[144:147], a[120:123], v[12:15]
  s_waitcnt lgkmcnt(2)
  ds_read_b128 a[120:123], v3 offset:1024
  v_add_f32 v9, v19, v9
  v_mfma_f32_16x16x32_bf16 v[92:95], v[44:47], a[148:151], v[92:95]
  v_cvt_pk_bf16_f32 v41, v18, v19
  v_mfma_f32_16x16x32_bf16 v[140:143], v[48:51], a[148:151], v[140:143]
  v_mfma_f32_16x16x32_bf16 v[188:191], v[52:55], a[148:151], v[188:191]
  v_mfma_f32_16x16x32_bf16 v[236:239], v[56:59], a[148:151], v[236:239]
  v_exp_f32 v12, v12
  v_mfma_f32_16x16x32_bf16 a[184:187], v[60:63], a[148:151], a[184:187]
  v_exp_f32 v13, v13
  v_mfma_f32_16x16x32_bf16 a[232:235], v[64:67], a[148:151], a[232:235]
  v_exp_f32 v14, v14
  v_mfma_f32_16x16x32_bf16 v[16:19], a[124:127], a[20:23], -4.0
  v_exp_f32 v15, v15
  v_mfma_f32_16x16x32_bf16 v[16:19], a[128:131], a[24:27], v[16:19]
  ds_read_b64_tr_b16 a[148:149], v1 offset:8384
  v_add_f32 v4, v12, v4
  v_mfma_f32_16x16x32_bf16 v[16:19], a[132:135], a[28:31], v[16:19]
  ds_read_b64_tr_b16 a[150:151], v1 offset:8896
  v_add_f32 v4, v13, v4
  v_mfma_f32_16x16x32_bf16 v[16:19], a[136:139], a[32:35], v[16:19]
  v_cvt_pk_bf16_f32 v22, v12, v13
  v_mfma_f32_16x16x32_bf16 v[16:19], a[140:143], a[36:39], v[16:19]
  s_waitcnt lgkmcnt(2)
  v_add_f32 v4, v14, v4
  v_mfma_f32_16x16x32_bf16 v[16:19], a[144:147], a[120:123], v[16:19]
  s_add_u32 m0, s96, 66944
  ds_read_b128 a[120:123], v3 offset:2048
  v_add_f32 v4, v15, v4
  v_mfma_f32_16x16x32_bf16 v[96:99], v[44:47], a[152:155], v[96:99]
  buffer_load_dwordx4 v2, s[20:23], s34 offen offset:128 nt lds
  v_mfma_f32_16x16x32_bf16 v[144:147], v[48:51], a[152:155], v[144:147]
  v_cvt_pk_bf16_f32 v23, v14, v15
  v_mfma_f32_16x16x32_bf16 v[192:195], v[52:55], a[152:155], v[192:195]
  v_mfma_f32_16x16x32_bf16 v[240:243], v[56:59], a[152:155], v[240:243]
  v_exp_f32 v16, v16
  v_mfma_f32_16x16x32_bf16 a[188:191], v[60:63], a[152:155], a[188:191]
  v_exp_f32 v17, v17
  v_mfma_f32_16x16x32_bf16 a[236:239], v[64:67], a[152:155], a[236:239]
  v_exp_f32 v18, v18
  v_mfma_f32_16x16x32_bf16 v[12:15], a[124:127], a[40:43], -4.0
  v_exp_f32 v19, v19
  v_mfma_f32_16x16x32_bf16 v[12:15], a[128:131], a[44:47], v[12:15]
  ds_read_b64_tr_b16 a[152:153], v1 offset:8400
  v_add_f32 v5, v16, v5
  v_mfma_f32_16x16x32_bf16 v[12:15], a[132:135], a[48:51], v[12:15]
  ds_read_b64_tr_b16 a[154:155], v1 offset:8912
  v_add_f32 v5, v17, v5
  v_mfma_f32_16x16x32_bf16 v[12:15], a[136:139], a[52:55], v[12:15]
  v_cvt_pk_bf16_f32 v26, v16, v17
  v_mfma_f32_16x16x32_bf16 v[12:15], a[140:143], a[56:59], v[12:15]
  s_waitcnt lgkmcnt(2)
  v_add_f32 v5, v18, v5
  v_mfma_f32_16x16x32_bf16 v[12:15], a[144:147], a[120:123], v[12:15]
  s_add_u32 m0, s96, 71008
  ds_read_b128 a[120:123], v3 offset:3072
  v_add_f32 v5, v19, v5
  v_mfma_f32_16x16x32_bf16 v[100:103], v[44:47], a[148:151], v[100:103]
  buffer_load_dwordx4 v2, s[20:23], s34 offen offset:256 nt lds
  v_mfma_f32_16x16x32_bf16 v[148:151], v[48:51], a[148:151], v[148:151]
  v_cvt_pk_bf16_f32 v27, v18, v19
  v_mfma_f32_16x16x32_bf16 v[196:199], v[52:55], a[148:151], v[196:199]
  v_mfma_f32_16x16x32_bf16 v[244:247], v[56:59], a[148:151], v[244:247]
  v_exp_f32 v12, v12
  v_mfma_f32_16x16x32_bf16 a[192:195], v[60:63], a[148:151], a[192:195]
  v_exp_f32 v13, v13
  v_mfma_f32_16x16x32_bf16 a[240:243], v[64:67], a[148:151], a[240:243]
  v_exp_f32 v14, v14
  v_mfma_f32_16x16x32_bf16 v[16:19], a[124:127], a[60:63], -4.0
  s_add_u32 s35, s35, 12576
  v_exp_f32 v15, v15
  v_mfma_f32_16x16x32_bf16 v[16:19], a[128:131], a[64:67], v[16:19]
  s_cmp_eq_u32 s35, s54
  ds_read_b64_tr_b16 a[148:149], v1 offset:8416
  v_add_f32 v6, v12, v6
  v_mfma_f32_16x16x32_bf16 v[16:19], a[132:135], a[68:71], v[16:19]
  s_cselect_b32 s35, s41, s35
  ds_read_b64_tr_b16 a[150:151], v1 offset:8928
  v_add_f32 v6, v13, v6
  v_mfma_f32_16x16x32_bf16 v[16:19], a[136:139], a[72:75], v[16:19]
  s_add_u32 s37, s36, 12576
  v_cvt_pk_bf16_f32 v30, v12, v13
  v_mfma_f32_16x16x32_bf16 v[16:19], a[140:143], a[76:79], v[16:19]
  s_waitcnt lgkmcnt(2)
  v_add_f32 v6, v14, v6
  v_mfma_f32_16x16x32_bf16 v[16:19], a[144:147], a[120:123], v[16:19]
  ds_read_b128 a[120:123], v3 offset:4096
  v_add_f32 v6, v15, v6
  v_mfma_f32_16x16x32_bf16 v[104:107], v[44:47], a[152:155], v[104:107]
  s_cmp_eq_u32 s37, 62880
  v_mfma_f32_16x16x32_bf16 v[152:155], v[48:51], a[152:155], v[152:155]
  s_cselect_b32 s37, 0, s37
  v_cvt_pk_bf16_f32 v31, v14, v15
  v_mfma_f32_16x16x32_bf16 v[200:203], v[52:55], a[152:155], v[200:203]
  s_sub_u32 s38, s37, s36
  v_mfma_f32_16x16x32_bf16 v[248:251], v[56:59], a[152:155], v[248:251]
  s_mov_b32 s36, s37
  v_exp_f32 v16, v16
  v_mfma_f32_16x16x32_bf16 a[196:199], v[60:63], a[152:155], a[196:199]
  s_add_u32 s33, s33, 12288
  v_exp_f32 v17, v17
  v_mfma_f32_16x16x32_bf16 a[244:247], v[64:67], a[152:155], a[244:247]
  s_add_u32 s34, s34, 12288
  v_exp_f32 v18, v18
  v_mfma_f32_16x16x32_bf16 v[12:15], a[124:127], a[80:83], -4.0
  s_sub_u32 s96, s35, s3
  v_exp_f32 v19, v19
  v_mfma_f32_16x16x32_bf16 v[12:15], a[128:131], a[84:87], v[12:15]
  ds_read_b64_tr_b16 a[152:153], v1 offset:8432
  v_add_f32 v7, v16, v7
  v_mfma_f32_16x16x32_bf16 v[12:15], a[132:135], a[88:91], v[12:15]
  ds_read_b64_tr_b16 a[154:155], v1 offset:8944
  v_add_f32 v7, v17, v7
  v_mfma_f32_16x16x32_bf16 v[12:15], a[136:139], a[92:95], v[12:15]
  v_cvt_pk_bf16_f32 v34, v16, v17
  v_mfma_f32_16x16x32_bf16 v[12:15], a[140:143], a[96:99], v[12:15]
  s_waitcnt lgkmcnt(2)
  v_add_f32 v7, v18, v7
  v_mfma_f32_16x16x32_bf16 v[12:15], a[144:147], a[120:123], v[12:15]
  ds_read_b128 a[120:123], v3 offset:5120
  v_add_f32 v7, v19, v7
  v_mfma_f32_16x16x32_bf16 v[108:111], v[44:47], a[148:151], v[108:111]
  v_add_u32 v0, s38, v0
  v_add_u32 v1, s38, v1
  v_mfma_f32_16x16x32_bf16 v[156:159], v[48:51], a[148:151], v[156:159]
  s_waitcnt vmcnt(6) lgkmcnt(1)
  v_cvt_pk_bf16_f32 v35, v18, v19
  v_mfma_f32_16x16x32_bf16 v[204:207], v[52:55], a[148:151], v[204:207]
  s_barrier
  v_mfma_f32_16x16x32_bf16 v[252:255], v[56:59], a[148:151], v[252:255]
  v_exp_f32 v12, v12
  v_mfma_f32_16x16x32_bf16 a[200:203], v[60:63], a[148:151], a[200:203]
  v_exp_f32 v13, v13
  v_mfma_f32_16x16x32_bf16 a[248:251], v[64:67], a[148:151], a[248:251]
  v_exp_f32 v14, v14
  v_mfma_f32_16x16x32_bf16 v[16:19], a[124:127], a[100:103], -4.0
  v_exp_f32 v15, v15
  v_mfma_f32_16x16x32_bf16 v[16:19], a[128:131], a[104:107], v[16:19]
  ds_read_b128 a[124:127], v0 offset:0
  v_add_f32 v8, v12, v8
  v_mfma_f32_16x16x32_bf16 v[16:19], a[132:135], a[108:111], v[16:19]
  ds_read_b128 a[128:131], v0 offset:64
  v_add_f32 v8, v13, v8
  v_mfma_f32_16x16x32_bf16 v[16:19], a[136:139], a[112:115], v[16:19]
  ds_read_b128 a[132:135], v0 offset:4192
  v_cvt_pk_bf16_f32 v38, v12, v13
  v_mfma_f32_16x16x32_bf16 v[16:19], a[140:143], a[116:119], v[16:19]
  s_waitcnt lgkmcnt(3)
  ds_read_b128 a[136:139], v0 offset:4256
  v_add_f32 v8, v14, v8
  v_mfma_f32_16x16x32_bf16 v[16:19], a[144:147], a[120:123], v[16:19]
  ds_read_b128 a[140:143], v0 offset:8384
  v_add_f32 v8, v15, v8
  v_mfma_f32_16x16x32_bf16 v[112:115], v[44:47], a[152:155], v[112:115]
  ds_read_b128 a[144:147], v0 offset:8448
  v_cvt_pk_bf16_f32 v39, v14, v15
  v_mfma_f32_16x16x32_bf16 v[160:163], v[48:51], a[152:155], v[160:163]
  ds_read_b128 a[120:123], v3 offset:0
  s_sub_u32 s39, s39, 1
  v_mfma_f32_16x16x32_bf16 v[208:211], v[52:55], a[152:155], v[208:211]
  ds_read_b64_tr_b16 a[148:149], v1 offset:0
  v_mfma_f32_16x16x32_bf16 a[156:159], v[56:59], a[152:155], a[156:159]
  ds_read_b64_tr_b16 a[150:151], v1 offset:512
  v_mfma_f32_16x16x32_bf16 a[204:207], v[60:63], a[152:155], a[204:207]
  v_exp_f32 v16, v16
  v_mfma_f32_16x16x32_bf16 a[252:255], v[64:67], a[152:155], a[252:255]
  s_waitcnt lgkmcnt(8)
  v_exp_f32 v17, v17
  v_mfma_f32_16x16x32_bf16 v[12:15], a[124:127], a[0:3], -4.0
  s_waitcnt lgkmcnt(7)
  v_exp_f32 v18, v18
  v_mfma_f32_16x16x32_bf16 v[12:15], a[128:131], a[4:7], v[12:15]
  s_waitcnt lgkmcnt(6)
  v_exp_f32 v19, v19
  v_mfma_f32_16x16x32_bf16 v[12:15], a[132:135], a[8:11], v[12:15]
  s_waitcnt lgkmcnt(5)
  ds_read_b64_tr_b16 a[152:153], v1 offset:16
  v_add_f32 v9, v16, v9
  v_mfma_f32_16x16x32_bf16 v[12:15], a[136:139], a[12:15], v[12:15]
  s_waitcnt lgkmcnt(5)
  ds_read_b64_tr_b16 a[154:155], v1 offset:528
  v_add_f32 v9, v17, v9
  v_mfma_f32_16x16x32_bf16 v[12:15], a[140:143], a[16:19], v[12:15]
  s_waitcnt lgkmcnt(4)
  v_cvt_pk_bf16_f32 v42, v16, v17
  v_add_f32 v9, v18, v9
  v_mfma_f32_16x16x32_bf16 v[12:15], a[144:147], a[120:123], v[12:15]
  s_waitcnt lgkmcnt(2)
  ds_read_b128 a[120:123], v3 offset:1024
  v_add_f32 v9, v19, v9
  v_mfma_f32_16x16x32_bf16 v[68:71], v[20:23], a[148:151], v[68:71]
  v_cvt_pk_bf16_f32 v43, v18, v19
  v_mfma_f32_16x16x32_bf16 v[116:119], v[24:27], a[148:151], v[116:119]
  v_mfma_f32_16x16x32_bf16 v[164:167], v[28:31], a[148:151], v[164:167]
  v_mfma_f32_16x16x32_bf16 v[212:215], v[32:35], a[148:151], v[212:215]
  v_exp_f32 v12, v12
  v_mfma_f32_16x16x32_bf16 a[160:163], v[36:39], a[148:151], a[160:163]
  v_exp_f32 v13, v13
  v_mfma_f32_16x16x32_bf16 a[208:211], v[40:43], a[148:151], a[208:211]
  v_exp_f32 v14, v14
  v_mfma_f32_16x16x32_bf16 v[16:19], a[124:127], a[20:23], -4.0
  v_exp_f32 v15, v15
  v_mfma_f32_16x16x32_bf16 v[16:19], a[128:131], a[24:27], v[16:19]
  ds_read_b64_tr_b16 a[148:149], v1 offset:32
  v_add_f32 v4, v12, v4
  v_mfma_f32_16x16x32_bf16 v[16:19], a[132:135], a[28:31], v[16:19]
  ds_read_b64_tr_b16 a[150:151], v1 offset:544
  v_add_f32 v4, v13, v4
  v_mfma_f32_16x16x32_bf16 v[16:19], a[136:139], a[32:35], v[16:19]
  v_cvt_pk_bf16_f32 v44, v12, v13
  v_mfma_f32_16x16x32_bf16 v[16:19], a[140:143], a[36:39], v[16:19]
  s_waitcnt lgkmcnt(2)
  v_add_f32 v4, v14, v4
  v_mfma_f32_16x16x32_bf16 v[16:19], a[144:147], a[120:123], v[16:19]
  s_add_u32 m0, s35, 0
  ds_read_b128 a[120:123], v3 offset:2048
  v_add_f32 v4, v15, v4
  v_mfma_f32_16x16x32_bf16 v[72:75], v[20:23], a[152:155], v[72:75]
  buffer_load_dwordx4 v2, s[16:19], s33 offen offset:0 nt lds
  v_mfma_f32_16x16x32_bf16 v[120:123], v[24:27], a[152:155], v[120:123]
  v_cvt_pk_bf16_f32 v45, v14, v15
  v_mfma_f32_16x16x32_bf16 v[168:171], v[28:31], a[152:155], v[168:171]
  v_mfma_f32_16x16x32_bf16 v[216:219], v[32:35], a[152:155], v[216:219]
  v_exp_f32 v16, v16
  v_mfma_f32_16x16x32_bf16 a[164:167], v[36:39], a[152:155], a[164:167]
  v_exp_f32 v17, v17
  v_mfma_f32_16x16x32_bf16 a[212:215], v[40:43], a[152:155], a[212:215]
  v_exp_f32 v18, v18
  v_mfma_f32_16x16x32_bf16 v[12:15], a[124:127], a[40:43], -4.0
  v_exp_f32 v19, v19
  v_mfma_f32_16x16x32_bf16 v[12:15], a[128:131], a[44:47], v[12:15]
  ds_read_b64_tr_b16 a[152:153], v1 offset:48
  v_add_f32 v5, v16, v5
  v_mfma_f32_16x16x32_bf16 v[12:15], a[132:135], a[48:51], v[12:15]
  ds_read_b64_tr_b16 a[154:155], v1 offset:560
  v_add_f32 v5, v17, v5
  v_mfma_f32_16x16x32_bf16 v[12:15], a[136:139], a[52:55], v[12:15]
  v_cvt_pk_bf16_f32 v48, v16, v17
  v_mfma_f32_16x16x32_bf16 v[12:15], a[140:143], a[56:59], v[12:15]
  s_waitcnt lgkmcnt(2)
  v_add_f32 v5, v18, v5
  v_mfma_f32_16x16x32_bf16 v[12:15], a[144:147], a[120:123], v[12:15]
  s_add_u32 m0, s35, 4064
  ds_read_b128 a[120:123], v3 offset:3072
  v_add_f32 v5, v19, v5
  v_mfma_f32_16x16x32_bf16 v[76:79], v[20:23], a[148:151], v[76:79]
  buffer_load_dwordx4 v2, s[16:19], s33 offen offset:128 nt lds
  v_mfma_f32_16x16x32_bf16 v[124:127], v[24:27], a[148:151], v[124:127]
  v_cvt_pk_bf16_f32 v49, v18, v19
  v_mfma_f32_16x16x32_bf16 v[172:175], v[28:31], a[148:151], v[172:175]
  v_mfma_f32_16x16x32_bf16 v[220:223], v[32:35], a[148:151], v[220:223]
  v_exp_f32 v12, v12
  v_mfma_f32_16x16x32_bf16 a[168:171], v[36:39], a[148:151], a[168:171]
  v_exp_f32 v13, v13
  v_mfma_f32_16x16x32_bf16 a[216:219], v[40:43], a[148:151], a[216:219]
  v_exp_f32 v14, v14
  v_mfma_f32_16x16x32_bf16 v[16:19], a[124:127], a[60:63], -4.0
  v_exp_f32 v15, v15
  v_mfma_f32_16x16x32_bf16 v[16:19], a[128:131], a[64:67], v[16:19]
  ds_read_b64_tr_b16 a[148:149], v1 offset:4192
  v_add_f32 v6, v12, v6
  v_mfma_f32_16x16x32_bf16 v[16:19], a[132:135], a[68:71], v[16:19]
  ds_read_b64_tr_b16 a[150:151], v1 offset:4704
  v_add_f32 v6, v13, v6
  v_mfma_f32_16x16x32_bf16 v[16:19], a[136:139], a[72:75], v[16:19]
  v_cvt_pk_bf16_f32 v52, v12, v13
  v_mfma_f32_16x16x32_bf16 v[16:19], a[140:143], a[76:79], v[16:19]
  s_waitcnt lgkmcnt(2)
  v_add_f32 v6, v14, v6
  v_mfma_f32_16x16x32_bf16 v[16:19], a[144:147], a[120:123], v[16:19]
  s_add_u32 m0, s35, 8128
  ds_read_b128 a[120:123], v3 offset:4096
  v_add_f32 v6, v15, v6
  v_mfma_f32_16x16x32_bf16 v[80:83], v[20:23], a[152:155], v[80:83]
  buffer_load_dwordx4 v2, s[16:19], s33 offen offset:256 nt lds
  v_mfma_f32_16x16x32_bf16 v[128:131], v[24:27], a[152:155], v[128:131]
  v_cvt_pk_bf16_f32 v53, v14, v15
  v_mfma_f32_16x16x32_bf16 v[176:179], v[28:31], a[152:155], v[176:179]
  v_mfma_f32_16x16x32_bf16 v[224:227], v[32:35], a[152:155], v[224:227]
  v_exp_f32 v16, v16
  v_mfma_f32_16x16x32_bf16 a[172:175], v[36:39], a[152:155], a[172:175]
  v_exp_f32 v17, v17
  v_mfma_f32_16x16x32_bf16 a[220:223], v[40:43], a[152:155], a[220:223]
  v_exp_f32 v18, v18
  v_mfma_f32_16x16x32_bf16 v[12:15], a[124:127], a[80:83], -4.0
  v_exp_f32 v19, v19
  v_mfma_f32_16x16x32_bf16 v[12:15], a[128:131], a[84:87], v[12:15]
  ds_read_b64_tr_b16 a[152:153], v1 offset:4208
  v_add_f32 v7, v16, v7
  v_mfma_f32_16x16x32_bf16 v[12:15], a[132:135], a[88:91], v[12:15]
  ds_read_b64_tr_b16 a[154:155], v1 offset:4720
  v_add_f32 v7, v17, v7
  v_mfma_f32_16x16x32_bf16 v[12:15], a[136:139], a[92:95], v[12:15]
  v_cvt_pk_bf16_f32 v56, v16, v17
  v_mfma_f32_16x16x32_bf16 v[12:15], a[140:143], a[96:99], v[12:15]
  s_waitcnt lgkmcnt(2)
  v_add_f32 v7, v18, v7
  v_mfma_f32_16x16x32_bf16 v[12:15], a[144:147], a[120:123], v[12:15]
  s_add_u32 m0, s96, 62880
  ds_read_b128 a[120:123], v3 offset:5120
  v_add_f32 v7, v19, v7
  v_mfma_f32_16x16x32_bf16 v[84:87], v[20:23], a[148:151], v[84:87]
  buffer_load_dwordx4 v2, s[20:23], s34 offen offset:0 nt lds
  v_mfma_f32_16x16x32_bf16 v[132:135], v[24:27], a[148:151], v[132:135]
  v_cvt_pk_bf16_f32 v57, v18, v19
  v_mfma_f32_16x16x32_bf16 v[180:183], v[28:31], a[148:151], v[180:183]
  v_mfma_f32_16x16x32_bf16 v[228:231], v[32:35], a[148:151], v[228:231]
  v_exp_f32 v12, v12
  v_mfma_f32_16x16x32_bf16 a[176:179], v[36:39], a[148:151], a[176:179]
  v_exp_f32 v13, v13
  v_mfma_f32_16x16x32_bf16 a[224:227], v[40:43], a[148:151], a[224:227]
  v_exp_f32 v14, v14
  v_mfma_f32_16x16x32_bf16 v[16:19], a[124:127], a[100:103], -4.0
  v_exp_f32 v15, v15
  v_mfma_f32_16x16x32_bf16 v[16:19], a[128:131], a[104:107], v[16:19]
  ds_read_b128 a[124:127], v0 offset:512
  v_add_f32 v8, v12, v8
  v_mfma_f32_16x16x32_bf16 v[16:19], a[132:135], a[108:111], v[16:19]
  ds_read_b128 a[128:131], v0 offset:576
  v_add_f32 v8, v13, v8
  v_mfma_f32_16x16x32_bf16 v[16:19], a[136:139], a[112:115], v[16:19]
  ds_read_b128 a[132:135], v0 offset:4704
  v_cvt_pk_bf16_f32 v60, v12, v13
  v_mfma_f32_16x16x32_bf16 v[16:19], a[140:143], a[116:119], v[16:19]
  s_waitcnt lgkmcnt(3)
  ds_read_b128 a[136:139], v0 offset:4768
  v_add_f32 v8, v14, v8
  v_mfma_f32_16x16x32_bf16 v[16:19], a[144:147], a[120:123], v[16:19]
  ds_read_b128 a[140:143], v0 offset:8896
  v_add_f32 v8, v15, v8
  v_mfma_f32_16x16x32_bf16 v[88:91], v[20:23], a[152:155], v[88:91]
  ds_read_b128 a[144:147], v0 offset:8960
  v_cvt_pk_bf16_f32 v61, v14, v15
  v_mfma_f32_16x16x32_bf16 v[136:139], v[24:27], a[152:155], v[136:139]
  ds_read_b128 a[120:123], v3 offset:0
  v_mfma_f32_16x16x32_bf16 v[184:187], v[28:31], a[152:155], v[184:187]
  ds_read_b64_tr_b16 a[148:149], v1 offset:4224
  v_mfma_f32_16x16x32_bf16 v[232:235], v[32:35], a[152:155], v[232:235]
  ds_read_b64_tr_b16 a[150:151], v1 offset:4736
  v_mfma_f32_16x16x32_bf16 a[180:183], v[36:39], a[152:155], a[180:183]
  v_exp_f32 v16, v16
  v_mfma_f32_16x16x32_bf16 a[228:231], v[40:43], a[152:155], a[228:231]
  s_waitcnt lgkmcnt(8)
  v_exp_f32 v17, v17
  v_mfma_f32_16x16x32_bf16 v[12:15], a[124:127], a[0:3], -4.0
  s_waitcnt lgkmcnt(7)
  v_exp_f32 v18, v18
  v_mfma_f32_16x16x32_bf16 v[12:15], a[128:131], a[4:7], v[12:15]
  s_waitcnt lgkmcnt(6)
  v_exp_f32 v19, v19
  v_mfma_f32_16x16x32_bf16 v[12:15], a[132:135], a[8:11], v[12:15]
  s_waitcnt lgkmcnt(5)
  ds_read_b64_tr_b16 a[152:153], v1 offset:4240
  v_add_f32 v9, v16, v9
  v_mfma_f32_16x16x32_bf16 v[12:15], a[136:139], a[12:15], v[12:15]
  s_waitcnt lgkmcnt(5)
  ds_read_b64_tr_b16 a[154:155], v1 offset:4752
  v_add_f32 v9, v17, v9
  v_mfma_f32_16x16x32_bf16 v[12:15], a[140:143], a[16:19], v[12:15]
  s_waitcnt lgkmcnt(4)
  v_cvt_pk_bf16_f32 v64, v16, v17
  v_add_f32 v9, v18, v9
  v_mfma_f32_16x16x32_bf16 v[12:15], a[144:147], a[120:123], v[12:15]
  s_waitcnt lgkmcnt(2)
  ds_read_b128 a[120:123], v3 offset:1024
  v_add_f32 v9, v19, v9
  v_mfma_f32_16x16x32_bf16 v[92:95], v[20:23], a[148:151], v[92:95]
  v_cvt_pk_bf16_f32 v65, v18, v19
  v_mfma_f32_16x16x32_bf16 v[140:143], v[24:27], a[148:151], v[140:143]
  v_mfma_f32_16x16x32_bf16 v[188:191], v[28:31], a[148:151], v[188:191]
  v_mfma_f32_16x16x32_bf16 v[236:239], v[32:35], a[148:151], v[236:239]
  v_exp_f32 v12, v12
  v_mfma_f32_16x16x32_bf16 a[184:187], v[36:39], a[148:151], a[184:187]
  v_exp_f32 v13, v13
  v_mfma_f32_16x16x32_bf16 a[232:235], v[40:43], a[148:151], a[232:235]
  v_exp_f32 v14, v14
  v_mfma_f32_16x16x32_bf16 v[16:19], a[124:127], a[20:23], -4.0
  v_exp_f32 v15, v15
  v_mfma_f32_16x16x32_bf16 v[16:19], a[128:131], a[24:27], v[16:19]
  ds_read_b64_tr_b16 a[148:149], v1 offset:8384
  v_add_f32 v4, v12, v4
  v_mfma_f32_16x16x32_bf16 v[16:19], a[132:135], a[28:31], v[16:19]
  ds_read_b64_tr_b16 a[150:151], v1 offset:8896
  v_add_f32 v4, v13, v4
  v_mfma_f32_16x16x32_bf16 v[16:19], a[136:139], a[32:35], v[16:19]
  v_cvt_pk_bf16_f32 v46, v12, v13
  v_mfma_f32_16x16x32_bf16 v[16:19], a[140:143], a[36:39], v[16:19]
  s_waitcnt lgkmcnt(2)
  v_add_f32 v4, v14, v4
  v_mfma_f32_16x16x32_bf16 v[16:19], a[144:147], a[120:123], v[16:19]
  s_add_u32 m0, s96, 66944
  ds_read_b128 a[120:123], v3 offset:2048
  v_add_f32 v4, v15, v4
  v_mfma_f32_16x16x32_bf16 v[96:99], v[20:23], a[152:155], v[96:99]
  buffer_load_dwordx4 v2, s[20:23], s34 offen offset:128 nt lds
  v_mfma_f32_16x16x32_bf16 v[144:147], v[24:27], a[152:155], v[144:147]
  v_cvt_pk_bf16_f32 v47, v14, v15
  v_mfma_f32_16x16x32_bf16 v[192:195], v[28:31], a[152:155], v[192:195]
  v_mfma_f32_16x16x32_bf16 v[240:243], v[32:35], a[152:155], v[240:243]
  v_exp_f32 v16, v16
  v_mfma_f32_16x16x32_bf16 a[188:191], v[36:39], a[152:155], a[188:191]
  v_exp_f32 v17, v17
  v_mfma_f32_16x16x32_bf16 a[236:239], v[40:43], a[152:155], a[236:239]
  v_exp_f32 v18, v18
  v_mfma_f32_16x16x32_bf16 v[12:15], a[124:127], a[40:43], -4.0
  v_exp_f32 v19, v19
  v_mfma_f32_16x16x32_bf16 v[12:15], a[128:131], a[44:47], v[12:15]
  ds_read_b64_tr_b16 a[152:153], v1 offset:8400
  v_add_f32 v5, v16, v5
  v_mfma_f32_16x16x32_bf16 v[12:15], a[132:135], a[48:51], v[12:15]
  ds_read_b64_tr_b16 a[154:155], v1 offset:8912
  v_add_f32 v5, v17, v5
  v_mfma_f32_16x16x32_bf16 v[12:15], a[136:139], a[52:55], v[12:15]
  v_cvt_pk_bf16_f32 v50, v16, v17
  v_mfma_f32_16x16x32_bf16 v[12:15], a[140:143], a[56:59], v[12:15]
  s_waitcnt lgkmcnt(2)
  v_add_f32 v5, v18, v5
  v_mfma_f32_16x16x32_bf16 v[12:15], a[144:147], a[120:123], v[12:15]
  s_add_u32 m0, s96, 71008
  ds_read_b128 a[120:123], v3 offset:3072
  v_add_f32 v5, v19, v5
  v_mfma_f32_16x16x32_bf16 v[100:103], v[20:23], a[148:151], v[100:103]
  buffer_load_dwordx4 v2, s[20:23], s34 offen offset:256 nt lds
  v_mfma_f32_16x16x32_bf16 v[148:151], v[24:27], a[148:151], v[148:151]
  v_cvt_pk_bf16_f32 v51, v18, v19
  v_mfma_f32_16x16x32_bf16 v[196:199], v[28:31], a[148:151], v[196:199]
  v_mfma_f32_16x16x32_bf16 v[244:247], v[32:35], a[148:151], v[244:247]
  v_exp_f32 v12, v12
  v_mfma_f32_16x16x32_bf16 a[192:195], v[36:39], a[148:151], a[192:195]
  v_exp_f32 v13, v13
  v_mfma_f32_16x16x32_bf16 a[240:243], v[40:43], a[148:151], a[240:243]
  v_exp_f32 v14, v14
  v_mfma_f32_16x16x32_bf16 v[16:19], a[124:127], a[60:63], -4.0
  s_add_u32 s35, s35, 12576
  v_exp_f32 v15, v15
  v_mfma_f32_16x16x32_bf16 v[16:19], a[128:131], a[64:67], v[16:19]
  s_cmp_eq_u32 s35, s54
  ds_read_b64_tr_b16 a[148:149], v1 offset:8416
  v_add_f32 v6, v12, v6
  v_mfma_f32_16x16x32_bf16 v[16:19], a[132:135], a[68:71], v[16:19]
  s_cselect_b32 s35, s41, s35
  ds_read_b64_tr_b16 a[150:151], v1 offset:8928
  v_add_f32 v6, v13, v6
  v_mfma_f32_16x16x32_bf16 v[16:19], a[136:139], a[72:75], v[16:19]
  s_add_u32 s37, s36, 12576
  v_cvt_pk_bf16_f32 v54, v12, v13
  v_mfma_f32_16x16x32_bf16 v[16:19], a[140:143], a[76:79], v[16:19]
  s_waitcnt lgkmcnt(2)
  v_add_f32 v6, v14, v6
  v_mfma_f32_16x16x32_bf16 v[16:19], a[144:147], a[120:123], v[16:19]
  ds_read_b128 a[120:123], v3 offset:4096
  v_add_f32 v6, v15, v6
  v_mfma_f32_16x16x32_bf16 v[104:107], v[20:23], a[152:155], v[104:107]
  s_cmp_eq_u32 s37, 62880
  v_mfma_f32_16x16x32_bf16 v[152:155], v[24:27], a[152:155], v[152:155]
  s_cselect_b32 s37, 0, s37
  v_cvt_pk_bf16_f32 v55, v14, v15
  v_mfma_f32_16x16x32_bf16 v[200:203], v[28:31], a[152:155], v[200:203]
  s_sub_u32 s38, s37, s36
  v_mfma_f32_16x16x32_bf16 v[248:251], v[32:35], a[152:155], v[248:251]
  s_mov_b32 s36, s37
  v_exp_f32 v16, v16
  v_mfma_f32_16x16x32_bf16 a[196:199], v[36:39], a[152:155], a[196:199]
  s_add_u32 s33, s33, 12288
  v_exp_f32 v17, v17
  v_mfma_f32_16x16x32_bf16 a[244:247], v[40:43], a[152:155], a[244:247]
  s_add_u32 s34, s34, 12288
  v_exp_f32 v18, v18
  v_mfma_f32_16x16x32_bf16 v[12:15], a[124:127], a[80:83], -4.0
  s_sub_u32 s96, s35, s3
  v_exp_f32 v19, v19
  v_mfma_f32_16x16x32_bf16 v[12:15], a[128:131], a[84:87], v[12:15]
  ds_read_b64_tr_b16 a[152:153], v1 offset:8432
  v_add_f32 v7, v16, v7
  v_mfma_f32_16x16x32_bf16 v[12:15], a[132:135], a[88:91], v[12:15]
  ds_read_b64_tr_b16 a[154:155], v1 offset:8944
  v_add_f32 v7, v17, v7
  v_mfma_f32_16x16x32_bf16 v[12:15], a[136:139], a[92:95], v[12:15]
  v_cvt_pk_bf16_f32 v58, v16, v17
  v_mfma_f32_16x16x32_bf16 v[12:15], a[140:143], a[96:99], v[12:15]
  s_waitcnt lgkmcnt(2)
  v_add_f32 v7, v18, v7
  v_mfma_f32_16x16x32_bf16 v[12:15], a[144:147], a[120:123], v[12:15]
  ds_read_b128 a[120:123], v3 offset:5120
  v_add_f32 v7, v19, v7
  v_mfma_f32_16x16x32_bf16 v[108:111], v[20:23], a[148:151], v[108:111]
  v_add_u32 v0, s38, v0
  v_add_u32 v1, s38, v1
  v_mfma_f32_16x16x32_bf16 v[156:159], v[24:27], a[148:151], v[156:159]
  s_waitcnt vmcnt(6) lgkmcnt(1)
  v_cvt_pk_bf16_f32 v59, v18, v19
  v_mfma_f32_16x16x32_bf16 v[204:207], v[28:31], a[148:151], v[204:207]
  s_barrier
  v_mfma_f32_16x16x32_bf16 v[252:255], v[32:35], a[148:151], v[252:255]
  v_exp_f32 v12, v12
  v_mfma_f32_16x16x32_bf16 a[200:203], v[36:39], a[148:151], a[200:203]
  v_exp_f32 v13, v13
  v_mfma_f32_16x16x32_bf16 a[248:251], v[40:43], a[148:151], a[248:251]
  v_exp_f32 v14, v14
  v_mfma_f32_16x16x32_bf16 v[16:19], a[124:127], a[100:103], -4.0
  v_exp_f32 v15, v15
  v_mfma_f32_16x16x32_bf16 v[16:19], a[128:131], a[104:107], v[16:19]
  ds_read_b128 a[124:127], v0 offset:0
  v_add_f32 v8, v12, v8
  v_mfma_f32_16x16x32_bf16 v[16:19], a[132:135], a[108:111], v[16:19]
  ds_read_b128 a[128:131], v0 offset:64
  v_add_f32 v8, v13, v8
  v_mfma_f32_16x16x32_bf16 v[16:19], a[136:139], a[112:115], v[16:19]
  ds_read_b128 a[132:135], v0 offset:4192
  v_cvt_pk_bf16_f32 v62, v12, v13
  v_mfma_f32_16x16x32_bf16 v[16:19], a[140:143], a[116:119], v[16:19]
  s_waitcnt lgkmcnt(3)
  ds_read_b128 a[136:139], v0 offset:4256
  v_add_f32 v8, v14, v8
  v_mfma_f32_16x16x32_bf16 v[16:19], a[144:147], a[120:123], v[16:19]
  ds_read_b128 a[140:143], v0 offset:8384
  v_add_f32 v8, v15, v8
  v_mfma_f32_16x16x32_bf16 v[112:115], v[20:23], a[152:155], v[112:115]
  ds_read_b128 a[144:147], v0 offset:8448
  v_cvt_pk_bf16_f32 v63, v14, v15
  v_mfma_f32_16x16x32_bf16 v[160:163], v[24:27], a[152:155], v[160:163]
  ds_read_b128 a[120:123], v3 offset:0
  s_cmp_eq_u32 s39, 0
  v_mfma_f32_16x16x32_bf16 v[208:211], v[28:31], a[152:155], v[208:211]
  ds_read_b64_tr_b16 a[148:149], v1 offset:0
  v_mfma_f32_16x16x32_bf16 a[156:159], v[32:35], a[152:155], a[156:159]
  ds_read_b64_tr_b16 a[150:151], v1 offset:512
  v_mfma_f32_16x16x32_bf16 a[204:207], v[36:39], a[152:155], a[204:207]
  s_waitcnt lgkmcnt(8)
  v_exp_f32 v16, v16
  v_mfma_f32_16x16x32_bf16 a[252:255], v[40:43], a[152:155], a[252:255]
  s_cbranch_scc1 L_drain
  v_exp_f32 v17, v17
  v_mfma_f32_16x16x32_bf16 v[12:15], a[124:127], a[0:3], -4.0
  s_waitcnt lgkmcnt(7)
  v_exp_f32 v18, v18
  v_mfma_f32_16x16x32_bf16 v[12:15], a[128:131], a[4:7], v[12:15]
  s_waitcnt lgkmcnt(6)
  v_exp_f32 v19, v19
  v_mfma_f32_16x16x32_bf16 v[12:15], a[132:135], a[8:11], v[12:15]
  s_waitcnt lgkmcnt(5)
  ds_read_b64_tr_b16 a[152:153], v1 offset:16
  v_add_f32 v9, v16, v9
  v_mfma_f32_16x16x32_bf16 v[12:15], a[136:139], a[12:15], v[12:15]
  s_waitcnt lgkmcnt(5)
  ds_read_b64_tr_b16 a[154:155], v1 offset:528
  v_add_f32 v9, v17, v9
  v_mfma_f32_16x16x32_bf16 v[12:15], a[140:143], a[16:19], v[12:15]
  s_waitcnt lgkmcnt(4)
  v_cvt_pk_bf16_f32 v66, v16, v17
  v_add_f32 v9, v18, v9
  v_mfma_f32_16x16x32_bf16 v[12:15], a[144:147], a[120:123], v[12:15]
  s_waitcnt lgkmcnt(2)
  ds_read_b128 a[120:123], v3 offset:1024
  v_add_f32 v9, v19, v9
  v_mfma_f32_16x16x32_bf16 v[68:71], v[44:47], a[148:151], v[68:71]
  v_cvt_pk_bf16_f32 v67, v18, v19
  v_mfma_f32_16x16x32_bf16 v[116:119], v[48:51], a[148:151], v[116:119]
  s_branch L_top
L_drain:
  v_mfma_f32_16x16x32_bf16 v[12:15], a[124:127], a[0:3], -4.0
  s_waitcnt lgkmcnt(7)
  v_exp_f32 v17, v17
  v_mfma_f32_16x16x32_bf16 v[12:15], a[128:131], a[4:7], v[12:15]
  s_waitcnt lgkmcnt(6)
  s_add_u32 m0, s96, 62880
  v_exp_f32 v18, v18
  v_mfma_f32_16x16x32_bf16 v[12:15], a[132:135], a[8:11], v[12:15]
  s_waitcnt lgkmcnt(4)
  s_waitcnt lgkmcnt(5)
  buffer_load_dwordx4 v2, s[20:23], s34 offen offset:0 nt lds
  v_mfma_f32_16x16x32_bf16 v[12:15], a[136:139], a[12:15], v[12:15]
  s_add_u32 m0, s96, 66944
  v_exp_f32 v19, v19
  v_mfma_f32_16x16x32_bf16 v[12:15], a[140:143], a[16:19], v[12:15]
  s_waitcnt lgkmcnt(2)
  buffer_load_dwordx4 v2, s[20:23], s34 offen offset:128 nt lds
  v_add_f32 v9, v16, v9
  v_mfma_f32_16x16x32_bf16 v[12:15], a[144:147], a[120:123], v[12:15]
  s_waitcnt lgkmcnt(0)
  s_add_u32 m0, s96, 71008
  ds_read_b128 a[120:123], v3 offset:1024
  v_add_f32 v9, v17, v9
  v_mfma_f32_16x16x32_bf16 v[68:71], v[44:47], a[148:151], v[68:71]
  buffer_load_dwordx4 v2, s[20:23], s34 offen offset:256 nt lds
  v_cvt_pk_bf16_f32 v66, v16, v17
  v_mfma_f32_16x16x32_bf16 v[116:119], v[48:51], a[148:151], v[116:119]
  v_add_f32 v9, v18, v9
  v_add_f32 v9, v19, v9
  v_mfma_f32_16x16x32_bf16 v[164:167], v[52:55], a[148:151], v[164:167]
  ds_read_b64_tr_b16 a[152:153], v1 offset:16
  v_cvt_pk_bf16_f32 v67, v18, v19
  v_mfma_f32_16x16x32_bf16 v[212:215], v[56:59], a[148:151], v[212:215]
  ds_read_b64_tr_b16 a[154:155], v1 offset:528
  v_mfma_f32_16x16x32_bf16 v[16:19], a[124:127], a[20:23], -4.0
  ds_read_b64_tr_b16 v[36:37], v1 offset:32
  v_mfma_f32_16x16x32_bf16 v[16:19], a[128:131], a[24:27], v[16:19]
  ds_read_b64_tr_b16 v[38:39], v1 offset:544
  v_mfma_f32_16x16x32_bf16 v[16:19], a[132:135], a[28:31], v[16:19]
  v_exp_f32 v12, v12
  v_mfma_f32_16x16x32_bf16 v[16:19], a[136:139], a[32:35], v[16:19]
  v_exp_f32 v13, v13
  v_mfma_f32_16x16x32_bf16 v[16:19], a[140:143], a[36:39], v[16:19]
  s_waitcnt lgkmcnt(4)
  v_exp_f32 v14, v14
  v_mfma_f32_16x16x32_bf16 v[16:19], a[144:147], a[120:123], v[16:19]
  s_waitcnt lgkmcnt(2)
  v_exp_f32 v15, v15
  v_mfma_f32_16x16x32_bf16 v[72:75], v[44:47], a[152:155], v[72:75]
  v_cvt_pk_bf16_f32 v20, v12, v13
  v_add_f32 v4, v12, v4
  v_mfma_f32_16x16x32_bf16 v[120:123], v[48:51], a[152:155], v[120:123]
  v_cvt_pk_bf16_f32 v21, v14, v15
  v_add_f32 v4, v13, v4
  v_mfma_f32_16x16x32_bf16 v[168:171], v[52:55], a[152:155], v[168:171]
  ds_read_b128 a[120:123], v3 offset:2048
  v_add_f32 v4, v14, v4
  v_mfma_f32_16x16x32_bf16 v[216:219], v[56:59], a[152:155], v[216:219]
  s_waitcnt lgkmcnt(1)
  ds_read_b64_tr_b16 v[40:41], v1 offset:48
  v_add_f32 v4, v15, v4
  v_mfma_f32_16x16x32_bf16 v[76:79], v[44:47], v[36:39], v[76:79]
  ds_read_b64_tr_b16 v[42:43], v1 offset:560
  v_mfma_f32_16x16x32_bf16 v[124:127], v[48:51], v[36:39], v[124:127]
  v_exp_f32 v16, v16
  v_mfma_f32_16x16x32_bf16 v[172:175], v[52:55], v[36:39], v[172:175]
  v_exp_f32 v17, v17
  v_mfma_f32_16x16x32_bf16 v[220:223], v[56:59], v[36:39], v[220:223]
  v_exp_f32 v18, v18
  v_mfma_f32_16x16x32_bf16 v[12:15], a[124:127], a[40:43], -4.0
  v_exp_f32 v19, v19
  v_mfma_f32_16x16x32_bf16 v[12:15], a[128:131], a[44:47], v[12:15]
  v_cvt_pk_bf16_f32 v24, v16, v17
  v_add_f32 v5, v16, v5
  v_mfma_f32_16x16x32_bf16 v[12:15], a[132:135], a[48:51], v[12:15]
  v_cvt_pk_bf16_f32 v25, v18, v19
  v_add_f32 v5, v17, v5
  v_mfma_f32_16x16x32_bf16 v[12:15], a[136:139], a[52:55], v[12:15]
  v_add_f32 v5, v18, v5
  v_add_f32 v5, v19, v5
  v_mfma_f32_16x16x32_bf16 v[12:15], a[140:143], a[56:59], v[12:15]
  s_waitcnt lgkmcnt(2)
  ds_read_b64_tr_b16 a[148:149], v1 offset:4192
  v_mfma_f32_16x16x32_bf16 v[12:15], a[144:147], a[120:123], v[12:15]
  s_waitcnt lgkmcnt(1)
  ds_read_b128 a[120:123], v3 offset:3072
  v_mfma_f32_16x16x32_bf16 v[80:83], v[44:47], v[40:43], v[80:83]
  ds_read_b64_tr_b16 a[150:151], v1 offset:4704
  v_mfma_f32_16x16x32_bf16 v[128:131], v[48:51], v[40:43], v[128:131]
  ds_read_b64_tr_b16 a[152:153], v1 offset:4208
  v_mfma_f32_16x16x32_bf16 v[176:179], v[52:55], v[40:43], v[176:179]
  ds_read_b64_tr_b16 a[154:155], v1 offset:4720
  v_mfma_f32_16x16x32_bf16 v[224:227], v[56:59], v[40:43], v[224:227]
  v_exp_f32 v12, v12
  v_mfma_f32_16x16x32_bf16 v[16:19], a[124:127], a[60:63], -4.0
  ds_read_b128 a[124:127], v0 offset:512
  v_mfma_f32_16x16x32_bf16 v[16:19], a[128:131], a[64:67], v[16:19]
  ds_read_b128 a[128:131], v0 offset:576
  v_mfma_f32_16x16x32_bf16 v[16:19], a[132:135], a[68:71], v[16:19]
  v_exp_f32 v13, v13
  v_mfma_f32_16x16x32_bf16 v[16:19], a[136:139], a[72:75], v[16:19]
  ds_read_b128 a[132:135], v0 offset:4704
  v_mfma_f32_16x16x32_bf16 v[16:19], a[140:143], a[76:79], v[16:19]
  s_waitcnt lgkmcnt(6)
  v_exp_f32 v14, v14
  v_mfma_f32_16x16x32_bf16 v[16:19], a[144:147], a[120:123], v[16:19]
  s_waitcnt lgkmcnt(5)
  v_exp_f32 v15, v15
  v_mfma_f32_16x16x32_bf16 v[84:87], v[44:47], a[148:151], v[84:87]
  ds_read_b128 a[136:139], v0 offset:4768
  v_cvt_pk_bf16_f32 v28, v12, v13
  v_mfma_f32_16x16x32_bf16 v[132:135], v[48:51], a[148:151], v[132:135]
  ds_read_b128 a[140:143], v0 offset:8896
  v_add_f32 v6, v12, v6
  v_mfma_f32_16x16x32_bf16 v[180:183], v[52:55], a[148:151], v[180:183]
  v_cvt_pk_bf16_f32 v29, v14, v15
  v_add_f32 v6, v13, v6
  v_mfma_f32_16x16x32_bf16 v[228:231], v[56:59], a[148:151], v[228:231]
  s_waitcnt lgkmcnt(5)
  ds_read_b128 a[144:147], v0 offset:8960
  v_add_f32 v6, v14, v6
  v_mfma_f32_16x16x32_bf16 v[88:91], v[44:47], a[152:155], v[88:91]
  ds_read_b128 a[120:123], v3 offset:0
  v_add_f32 v6, v15, v6
  v_mfma_f32_16x16x32_bf16 v[136:139], v[48:51], a[152:155], v[136:139]
  ds_read_b64_tr_b16 v[36:37], v1 offset:4224
  v_mfma_f32_16x16x32_bf16 v[184:187], v[52:55], a[152:155], v[184:187]
  s_waitcnt lgkmcnt(5)
  ds_read_b64_tr_b16 v[38:39], v1 offset:4736
  v_mfma_f32_16x16x32_bf16 v[232:235], v[56:59], a[152:155], v[232:235]
  s_waitcnt lgkmcnt(8)
  v_exp_f32 v16, v16
  v_mfma_f32_16x16x32_bf16 v[12:15], a[124:127], a[0:3], -4.0
  s_waitcnt lgkmcnt(7)
  v_exp_f32 v17, v17
  v_mfma_f32_16x16x32_bf16 v[12:15], a[128:131], a[4:7], v[12:15]
  s_waitcnt vmcnt(3)
  v_exp_f32 v18, v18
  v_mfma_f32_16x16x32_bf16 v[12:15], a[132:135], a[8:11], v[12:15]
  s_barrier
  v_exp_f32 v19, v19
  s_waitcnt lgkmcnt(5)
  v_mfma_f32_16x16x32_bf16 v[12:15], a[136:139], a[12:15], v[12:15]
  s_waitcnt lgkmcnt(4)
  v_cvt_pk_bf16_f32 v32, v16, v17
  v_add_f32 v7, v16, v7
  v_mfma_f32_16x16x32_bf16 v[12:15], a[140:143], a[16:19], v[12:15]
  s_waitcnt lgkmcnt(2)
  v_cvt_pk_bf16_f32 v33, v18, v19
  v_add_f32 v7, v17, v7
  v_mfma_f32_16x16x32_bf16 v[12:15], a[144:147], a[120:123], v[12:15]
  s_waitcnt lgkmcnt(0)
  ds_read_b128 a[120:123], v3 offset:1024
  v_add_f32 v7, v18, v7
  v_mfma_f32_16x16x32_bf16 v[92:95], v[44:47], v[36:39], v[92:95]
  ds_read_b64_tr_b16 v[40:41], v1 offset:4240
  v_add_f32 v7, v19, v7
  v_mfma_f32_16x16x32_bf16 v[140:143], v[48:51], v[36:39], v[140:143]
  ds_read_b64_tr_b16 v[42:43], v1 offset:4752
  v_mfma_f32_16x16x32_bf16 v[188:191], v[52:55], v[36:39], v[188:191]
  ds_read_b64_tr_b16 a[148:149], v1 offset:8384
  v_mfma_f32_16x16x32_bf16 v[236:239], v[56:59], v[36:39], v[236:239]
  ds_read_b64_tr_b16 a[150:151], v1 offset:8896
  v_mfma_f32_16x16x32_bf16 v[16:19], a[124:127], a[20:23], -4.0
  v_exp_f32 v12, v12
  v_mfma_f32_16x16x32_bf16 v[16:19], a[128:131], a[24:27], v[16:19]
  v_exp_f32 v13, v13
  v_mfma_f32_16x16x32_bf16 v[16:19], a[132:135], a[28:31], v[16:19]
  v_exp_f32 v14, v14
  v_mfma_f32_16x16x32_bf16 v[16:19], a[136:139], a[32:35], v[16:19]
  v_exp_f32 v15, v15
  v_mfma_f32_16x16x32_bf16 v[16:19], a[140:143], a[36:39], v[16:19]
  s_waitcnt lgkmcnt(4)
  v_cvt_pk_bf16_f32 v22, v12, v13
  v_add_f32 v4, v12, v4
  v_mfma_f32_16x16x32_bf16 v[16:19], a[144:147], a[120:123], v[16:19]
  s_waitcnt lgkmcnt(2)
  v_cvt_pk_bf16_f32 v23, v14, v15
  v_add_f32 v4, v13, v4
  v_mfma_f32_16x16x32_bf16 v[96:99], v[44:47], v[40:43], v[96:99]
  ds_read_b128 a[120:123], v3 offset:2048
  v_add_f32 v4, v14, v4
  v_mfma_f32_16x16x32_bf16 v[144:147], v[48:51], v[40:43], v[144:147]
  ds_read_b64_tr_b16 a[152:153], v1 offset:8400
  v_add_f32 v4, v15, v4
  v_mfma_f32_16x16x32_bf16 v[192:195], v[52:55], v[40:43], v[192:195]
  ds_read_b64_tr_b16 a[154:155], v1 offset:8912
  v_mfma_f32_16x16x32_bf16 v[240:243], v[56:59], v[40:43], v[240:243]
  s_waitcnt lgkmcnt(3)
  v_exp_f32 v16, v16
  v_mfma_f32_16x16x32_bf16 v[100:103], v[44:47], a[148:151], v[100:103]
  v_exp_f32 v17, v17
  v_mfma_f32_16x16x32_bf16 v[148:151], v[48:51], a[148:151], v[148:151]
  v_exp_f32 v18, v18
  v_mfma_f32_16x16x32_bf16 v[196:199], v[52:55], a[148:151], v[196:199]
  v_exp_f32 v19, v19
  v_mfma_f32_16x16x32_bf16 v[244:247], v[56:59], a[148:151], v[244:247]
  v_cvt_pk_bf16_f32 v26, v16, v17
  v_add_f32 v5, v16, v5
  v_mfma_f32_16x16x32_bf16 v[12:15], a[124:127], a[40:43], -4.0
  v_cvt_pk_bf16_f32 v27, v18, v19
  v_add_f32 v5, v17, v5
  v_mfma_f32_16x16x32_bf16 v[12:15], a[128:131], a[44:47], v[12:15]
  v_add_f32 v5, v18, v5
  v_add_f32 v5, v19, v5
  v_mfma_f32_16x16x32_bf16 v[12:15], a[132:135], a[48:51], v[12:15]
  ds_read_b64_tr_b16 v[36:37], v1 offset:8416
  v_mfma_f32_16x16x32_bf16 v[12:15], a[136:139], a[52:55], v[12:15]
  ds_read_b64_tr_b16 v[38:39], v1 offset:8928
  v_mfma_f32_16x16x32_bf16 v[12:15], a[140:143], a[56:59], v[12:15]
  s_waitcnt lgkmcnt(4)
  ds_read_b64_tr_b16 v[40:41], v1 offset:8432
  v_mfma_f32_16x16x32_bf16 v[12:15], a[144:147], a[120:123], v[12:15]
  s_waitcnt lgkmcnt(3)
  ds_read_b128 a[120:123], v3 offset:3072
  v_mfma_f32_16x16x32_bf16 v[104:107], v[44:47], a[152:155], v[104:107]
  ds_read_b64_tr_b16 v[42:43], v1 offset:8944
  v_mfma_f32_16x16x32_bf16 v[152:155], v[48:51], a[152:155], v[152:155]
  ds_read_b64_tr_b16 a[148:149], v1 offset:12576
  v_mfma_f32_16x16x32_bf16 v[200:203], v[52:55], a[152:155], v[200:203]
  s_nop 0
  v_exp_f32 v12, v12
  v_mfma_f32_16x16x32_bf16 v[248:251], v[56:59], a[152:155], v[248:251]
  v_exp_f32 v13, v13
  v_mfma_f32_16x16x32_bf16 v[16:19], a[124:127], a[60:63], -4.0
  ds_read_b128 a[124:127], v0 offset:12576
  v_mfma_f32_16x16x32_bf16 v[16:19], a[128:131], a[64:67], v[16:19]
  ds_read_b128 a[128:131], v0 offset:12640
  v_mfma_f32_16x16x32_bf16 v[16:19], a[132:135], a[68:71], v[16:19]
  ds_read_b128 a[132:135], v0 offset:16768
  v_mfma_f32_16x16x32_bf16 v[16:19], a[136:139], a[72:75], v[16:19]
  v_exp_f32 v14, v14
  v_mfma_f32_16x16x32_bf16 v[16:19], a[140:143], a[76:79], v[16:19]
  s_waitcnt lgkmcnt(5)
  v_exp_f32 v15, v15
  v_mfma_f32_16x16x32_bf16 v[16:19], a[144:147], a[120:123], v[16:19]
  ds_read_b128 a[136:139], v0 offset:16832
  v_cvt_pk_bf16_f32 v30, v12, v13
  v_mfma_f32_16x16x32_bf16 v[108:111], v[44:47], v[36:39], v[108:111]
  ds_read_b128 a[140:143], v0 offset:20960
  v_add_f32 v6, v12, v6
  v_mfma_f32_16x16x32_bf16 v[156:159], v[48:51], v[36:39], v[156:159]
  v_cvt_pk_bf16_f32 v31, v14, v15
  v_add_f32 v6, v13, v6
  v_mfma_f32_16x16x32_bf16 v[204:207], v[52:55], v[36:39], v[204:207]
  ds_read_b128 a[144:147], v0 offset:21024
  v_add_f32 v6, v14, v6
  v_mfma_f32_16x16x32_bf16 v[252:255], v[56:59], v[36:39], v[252:255]
  s_waitcnt lgkmcnt(7)
  ds_read_b128 a[120:123], v3 offset:0
  v_add_f32 v6, v15, v6
  v_mfma_f32_16x16x32_bf16 v[112:115], v[44:47], v[40:43], v[112:115]
  ds_read_b64_tr_b16 a[150:151], v1 offset:13088
  v_mfma_f32_16x16x32_bf16 v[160:163], v[48:51], v[40:43], v[160:163]
  v_exp_f32 v16, v16
  v_mfma_f32_16x16x32_bf16 v[208:211], v[52:55], v[40:43], v[208:211]
  v_exp_f32 v17, v17
  v_mfma_f32_16x16x32_bf16 a[156:159], v[56:59], v[40:43], a[156:159]
  s_waitcnt lgkmcnt(7)
  v_exp_f32 v18, v18
  v_mfma_f32_16x16x32_bf16 v[12:15], a[124:127], a[0:3], -4.0
  s_waitcnt lgkmcnt(6)
  v_exp_f32 v19, v19
  v_mfma_f32_16x16x32_bf16 v[12:15], a[128:131], a[4:7], v[12:15]
  s_waitcnt lgkmcnt(5)
  v_cvt_pk_bf16_f32 v34, v16, v17
  v_add_f32 v7, v16, v7
  v_mfma_f32_16x16x32_bf16 v[12:15], a[132:135], a[8:11], v[12:15]
  s_waitcnt lgkmcnt(4)
  v_cvt_pk_bf16_f32 v35, v18, v19
  v_add_f32 v7, v17, v7
  v_mfma_f32_16x16x32_bf16 v[12:15], a[136:139], a[12:15], v[12:15]
  s_waitcnt lgkmcnt(3)
  v_add_f32 v7, v18, v7
  v_add_f32 v7, v19, v7
  v_mfma_f32_16x16x32_bf16 v[12:15], a[140:143], a[16:19], v[12:15]
  s_waitcnt lgkmcnt(1)
  ds_read_b64_tr_b16 a[152:153], v1 offset:12592
  v_mfma_f32_16x16x32_bf16 v[12:15], a[144:147], a[120:123], v[12:15]
  s_waitcnt lgkmcnt(1)
  ds_read_b128 a[120:123], v3 offset:1024
  v_mfma_f32_16x16x32_bf16 v[68:71], v[20:23], a[148:151], v[68:71]
  ds_read_b64_tr_b16 a[154:155], v1 offset:13104
  v_mfma_f32_16x16x32_bf16 v[116:119], v[24:27], a[148:151], v[116:119]
  ds_read_b64_tr_b16 v[36:37], v1 offset:12608
  v_mfma_f32_16x16x32_bf16 v[164:167], v[28:31], a[148:151], v[164:167]
  ds_read_b64_tr_b16 v[38:39], v1 offset:13120
  v_mfma_f32_16x16x32_bf16 v[212:215], v[32:35], a[148:151], v[212:215]
  v_exp_f32 v12, v12
  v_mfma_f32_16x16x32_bf16 v[16:19], a[124:127], a[20:23], -4.0
  v_exp_f32 v13, v13
  v_mfma_f32_16x16x32_bf16 v[16:19], a[128:131], a[24:27], v[16:19]
  v_exp_f32 v14, v14
  v_mfma_f32_16x16x32_bf16 v[16:19], a[132:135], a[28:31], v[16:19]
  v_exp_f32 v15, v15
  v_mfma_f32_16x16x32_bf16 v[16:19], a[136:139], a[32:35], v[16:19]
  v_cvt_pk_bf16_f32 v44, v12, v13
  v_add_f32 v4, v12, v4
  v_mfma_f32_16x16x32_bf16 v[16:19], a[140:143], a[36:39], v[16:19]
  s_waitcnt lgkmcnt(3)
  v_cvt_pk_bf16_f32 v45, v14, v15
  v_add_f32 v4, v13, v4
  v_mfma_f32_16x16x32_bf16 v[16:19], a[144:147], a[120:123], v[16:19]
  s_waitcnt lgkmcnt(2)
  ds_read_b128 a[120:123], v3 offset:2048
  v_add_f32 v4, v14, v4
  v_mfma_f32_16x16x32_bf16 v[72:75], v[20:23], a[152:155], v[72:75]
  ds_read_b64_tr_b16 v[40:41], v1 offset:12624
  v_add_f32 v4, v15, v4
  v_mfma_f32_16x16x32_bf16 v[120:123], v[24:27], a[152:155], v[120:123]
  ds_read_b64_tr_b16 v[42:43], v1 offset:13136
  v_mfma_f32_16x16x32_bf16 v[168:171], v[28:31], a[152:155], v[168:171]
  v_exp_f32 v16, v16
  v_mfma_f32_16x16x32_bf16 v[216:219], v[32:35], a[152:155], v[216:219]
  s_waitcnt lgkmcnt(3)
  v_exp_f32 v17, v17
  v_mfma_f32_16x16x32_bf16 v[76:79], v[20:23], v[36:39], v[76:79]
  v_exp_f32 v18, v18
  v_mfma_f32_16x16x32_bf16 v[124:127], v[24:27], v[36:39], v[124:127]
  v_exp_f32 v19, v19
  v_mfma_f32_16x16x32_bf16 v[172:175], v[28:31], v[36:39], v[172:175]
  v_cvt_pk_bf16_f32 v48, v16, v17
  v_add_f32 v5, v16, v5
  v_mfma_f32_16x16x32_bf16 v[220:223], v[32:35], v[36:39], v[220:223]
  v_cvt_pk_bf16_f32 v49, v18, v19
  v_add_f32 v5, v17, v5
  v_mfma_f32_16x16x32_bf16 v[12:15], a[124:127], a[40:43], -4.0
  v_add_f32 v5, v18, v5
  v_add_f32 v5, v19, v5
  v_mfma_f32_16x16x32_bf16 v[12:15], a[128:131], a[44:47], v[12:15]
  ds_read_b64_tr_b16 a[148:149], v1 offset:16768
  v_mfma_f32_16x16x32_bf16 v[12:15], a[132:135], a[48:51], v[12:15]
  ds_read_b64_tr_b16 a[150:151], v1 offset:17280
  v_mfma_f32_16x16x32_bf16 v[12:15], a[136:139], a[52:55], v[12:15]
  ds_read_b64_tr_b16 a[152:153], v1 offset:16784
  v_mfma_f32_16x16x32_bf16 v[12:15], a[140:143], a[56:59], v[12:15]
  s_waitcnt lgkmcnt(5)
  ds_read_b64_tr_b16 a[154:155], v1 offset:17296
  v_mfma_f32_16x16x32_bf16 v[12:15], a[144:147], a[120:123], v[12:15]
  s_waitcnt lgkmcnt(4)
  ds_read_b128 a[120:123], v3 offset:3072
  v_mfma_f32_16x16x32_bf16 v[80:83], v[20:23], v[40:43], v[80:83]
  ds_read_b64_tr_b16 v[36:37], v1 offset:16800
  v_mfma_f32_16x16x32_bf16 v[128:131], v[24:27], v[40:43], v[128:131]
  ds_read_b64_tr_b16 v[38:39], v1 offset:17312
  v_mfma_f32_16x16x32_bf16 v[176:179], v[28:31], v[40:43], v[176:179]
  s_nop 0
  v_exp_f32 v12, v12
  v_mfma_f32_16x16x32_bf16 v[224:227], v[32:35], v[40:43], v[224:227]
  v_exp_f32 v13, v13
  v_mfma_f32_16x16x32_bf16 v[16:19], a[124:127], a[60:63], -4.0
  ds_read_b128 a[124:127], v0 offset:13088
  v_mfma_f32_16x16x32_bf16 v[16:19], a[128:131], a[64:67], v[16:19]
  ds_read_b128 a[128:131], v0 offset:13152
  v_mfma_f32_16x16x32_bf16 v[16:19], a[132:135], a[68:71], v[16:19]
  ds_read_b128 a[132:135], v0 offset:17280
  v_mfma_f32_16x16x32_bf16 v[16:19], a[136:139], a[72:75], v[16:19]
  v_exp_f32 v14, v14
  v_mfma_f32_16x16x32_bf16 v[16:19], a[140:143], a[76:79], v[16:19]
  s_waitcnt lgkmcnt(5)
  v_exp_f32 v15, v15
  v_mfma_f32_16x16x32_bf16 v[16:19], a[144:147], a[120:123], v[16:19]
  ds_read_b128 a[136:139], v0 offset:17344
  v_cvt_pk_bf16_f32 v52, v12, v13
  v_mfma_f32_16x16x32_bf16 v[84:87], v[20:23], a[148:151], v[84:87]
  ds_read_b128 a[140:143], v0 offset:21472
  v_add_f32 v6, v12, v6
  v_mfma_f32_16x16x32_bf16 v[132:135], v[24:27], a[148:151], v[132:135]
  v_cvt_pk_bf16_f32 v53, v14, v15
  v_add_f32 v6, v13, v6
  v_mfma_f32_16x16x32_bf16 v[180:183], v[28:31], a[148:151], v[180:183]
  ds_read_b128 a[144:147], v0 offset:21536
  v_add_f32 v6, v14, v6
  v_mfma_f32_16x16x32_bf16 v[228:231], v[32:35], a[148:151], v[228:231]
  ds_read_b128 a[120:123], v3 offset:0
  v_add_f32 v6, v15, v6
  v_mfma_f32_16x16x32_bf16 v[88:91], v[20:23], a[152:155], v[88:91]
  v_exp_f32 v16, v16
  v_mfma_f32_16x16x32_bf16 v[136:139], v[24:27], a[152:155], v[136:139]
  v_exp_f32 v17, v17
  v_mfma_f32_16x16x32_bf16 v[184:187], v[28:31], a[152:155], v[184:187]
  v_exp_f32 v18, v18
  v_mfma_f32_16x16x32_bf16 v[232:235], v[32:35], a[152:155], v[232:235]
  s_waitcnt lgkmcnt(6)
  v_exp_f32 v19, v19
  v_mfma_f32_16x16x32_bf16 v[12:15], a[124:127], a[0:3], -4.0
  s_waitcnt lgkmcnt(5)
  v_cvt_pk_bf16_f32 v56, v16, v17
  v_add_f32 v7, v16, v7
  v_mfma_f32_16x16x32_bf16 v[12:15], a[128:131], a[4:7], v[12:15]
  s_waitcnt lgkmcnt(4)
  v_cvt_pk_bf16_f32 v57, v18, v19
  v_add_f32 v7, v17, v7
  v_mfma_f32_16x16x32_bf16 v[12:15], a[132:135], a[8:11], v[12:15]
  s_waitcnt lgkmcnt(3)
  v_add_f32 v7, v18, v7
  v_add_f32 v7, v19, v7
  v_mfma_f32_16x16x32_bf16 v[12:15], a[136:139], a[12:15], v[12:15]
  s_waitcnt lgkmcnt(2)
  ds_read_b64_tr_b16 v[40:41], v1 offset:16816
  v_mfma_f32_16x16x32_bf16 v[12:15], a[140:143], a[16:19], v[12:15]
  s_waitcnt lgkmcnt(1)
  ds_read_b64_tr_b16 v[42:43], v1 offset:17328
  v_mfma_f32_16x16x32_bf16 v[12:15], a[144:147], a[120:123], v[12:15]
  ds_read_b128 a[120:123], v3 offset:1024
  v_mfma_f32_16x16x32_bf16 v[92:95], v[20:23], v[36:39], v[92:95]
  ds_read_b64_tr_b16 a[148:149], v1 offset:20960
  v_mfma_f32_16x16x32_bf16 v[140:143], v[24:27], v[36:39], v[140:143]
  ds_read_b64_tr_b16 a[150:151], v1 offset:21472
  v_mfma_f32_16x16x32_bf16 v[188:191], v[28:31], v[36:39], v[188:191]
  s_nop 1
  v_exp_f32 v12, v12
  v_mfma_f32_16x16x32_bf16 v[236:239], v[32:35], v[36:39], v[236:239]
  v_exp_f32 v13, v13
  v_mfma_f32_16x16x32_bf16 v[16:19], a[124:127], a[20:23], -4.0
  v_exp_f32 v14, v14
  v_mfma_f32_16x16x32_bf16 v[16:19], a[128:131], a[24:27], v[16:19]
  v_exp_f32 v15, v15
  v_mfma_f32_16x16x32_bf16 v[16:19], a[132:135], a[28:31], v[16:19]
  v_cvt_pk_bf16_f32 v46, v12, v13
  v_add_f32 v4, v12, v4
  v_mfma_f32_16x16x32_bf16 v[16:19], a[136:139], a[32:35], v[16:19]
  v_cvt_pk_bf16_f32 v47, v14, v15
  v_add_f32 v4, v13, v4
  v_mfma_f32_16x16x32_bf16 v[16:19], a[140:143], a[36:39], v[16:19]
  s_waitcnt lgkmcnt(2)
  v_add_f32 v4, v14, v4
  v_add_f32 v4, v15, v4
  v_mfma_f32_16x16x32_bf16 v[16:19], a[144:147], a[120:123], v[16:19]
  ds_read_b128 a[120:123], v3 offset:2048
  v_mfma_f32_16x16x32_bf16 v[96:99], v[20:23], v[40:43], v[96:99]
  ds_read_b64_tr_b16 a[152:153], v1 offset:20976
  v_mfma_f32_16x16x32_bf16 v[144:147], v[24:27], v[40:43], v[144:147]
  s_waitcnt vmcnt(0)
  ds_read_b64_tr_b16 a[154:155], v1 offset:21488
  v_mfma_f32_16x16x32_bf16 v[192:195], v[28:31], v[40:43], v[192:195]
  s_barrier
  v_exp_f32 v16, v16
  v_mfma_f32_16x16x32_bf16 v[240:243], v[32:35], v[40:43], v[240:243]
  s_waitcnt lgkmcnt(3)
  v_exp_f32 v17, v17
  v_mfma_f32_16x16x32_bf16 v[100:103], v[20:23], a[148:151], v[100:103]
  v_exp_f32 v18, v18
  v_mfma_f32_16x16x32_bf16 v[148:151], v[24:27], a[148:151], v[148:151]
  v_exp_f32 v19, v19
  v_mfma_f32_16x16x32_bf16 v[196:199], v[28:31], a[148:151], v[196:199]
  v_cvt_pk_bf16_f32 v50, v16, v17
  v_add_f32 v5, v16, v5
  v_mfma_f32_16x16x32_bf16 v[244:247], v[32:35], a[148:151], v[244:247]
  v_cvt_pk_bf16_f32 v51, v18, v19
  v_add_f32 v5, v17, v5
  v_mfma_f32_16x16x32_bf16 v[12:15], a[124:127], a[40:43], -4.0
  v_add_f32 v5, v18, v5
  v_add_f32 v5, v19, v5
  v_mfma_f32_16x16x32_bf16 v[12:15], a[128:131], a[44:47], v[12:15]
  ds_read_b64_tr_b16 v[36:37], v1 offset:20992
  v_mfma_f32_16x16x32_bf16 v[12:15], a[132:135], a[48:51], v[12:15]
  ds_read_b64_tr_b16 v[38:39], v1 offset:21504
  v_mfma_f32_16x16x32_bf16 v[12:15], a[136:139], a[52:55], v[12:15]
  ds_read_b64_tr_b16 v[40:41], v1 offset:21008
  v_mfma_f32_16x16x32_bf16 v[12:15], a[140:143], a[56:59], v[12:15]
  s_waitcnt lgkmcnt(5)
  ds_read_b64_tr_b16 v[42:43], v1 offset:21520
  v_mfma_f32_16x16x32_bf16 v[12:15], a[144:147], a[120:123], v[12:15]
  ds_read_b128 a[120:123], v3 offset:3072
  v_mfma_f32_16x16x32_bf16 v[16:19], a[124:127], a[60:63], -4.0
  ds_read_b64_tr_b16 a[148:149], v1 offset:25152
  v_mfma_f32_16x16x32_bf16 v[16:19], a[128:131], a[64:67], v[16:19]
  ds_read_b64_tr_b16 a[150:151], v1 offset:25664
  v_mfma_f32_16x16x32_bf16 v[16:19], a[132:135], a[68:71], v[16:19]
  s_nop 1
  v_exp_f32 v12, v12
  v_mfma_f32_16x16x32_bf16 v[16:19], a[136:139], a[72:75], v[16:19]
  v_exp_f32 v13, v13
  v_mfma_f32_16x16x32_bf16 v[16:19], a[140:143], a[76:79], v[16:19]
  s_waitcnt lgkmcnt(2)
  v_exp_f32 v14, v14
  v_mfma_f32_16x16x32_bf16 v[16:19], a[144:147], a[120:123], v[16:19]
  v_exp_f32 v15, v15
  v_mfma_f32_16x16x32_bf16 v[104:107], v[20:23], a[152:155], v[104:107]
  v_cvt_pk_bf16_f32 v54, v12, v13
  v_add_f32 v6, v12, v6
  v_mfma_f32_16x16x32_bf16 v[152:155], v[24:27], a[152:155], v[152:155]
  v_cvt_pk_bf16_f32 v55, v14, v15
  v_add_f32 v6, v13, v6
  v_mfma_f32_16x16x32_bf16 v[200:203], v[28:31], a[152:155], v[200:203]
  v_add_f32 v6, v14, v6
  v_add_f32 v6, v15, v6
  v_mfma_f32_16x16x32_bf16 v[248:251], v[32:35], a[152:155], v[248:251]
  v_exp_f32 v16, v16
  v_mfma_f32_16x16x32_bf16 v[108:111], v[20:23], v[36:39], v[108:111]
  v_exp_f32 v17, v17
  v_mfma_f32_16x16x32_bf16 v[156:159], v[24:27], v[36:39], v[156:159]
  ds_read_b64_tr_b16 a[152:153], v1 offset:25168
  v_mfma_f32_16x16x32_bf16 v[204:207], v[28:31], v[36:39], v[204:207]
  ds_read_b64_tr_b16 a[154:155], v1 offset:25680
  v_mfma_f32_16x16x32_bf16 v[252:255], v[32:35], v[36:39], v[252:255]
  v_exp_f32 v18, v18
  v_mfma_f32_16x16x32_bf16 v[112:115], v[20:23], v[40:43], v[112:115]
  v_exp_f32 v19, v19
  v_mfma_f32_16x16x32_bf16 v[160:163], v[24:27], v[40:43], v[160:163]
  v_cvt_pk_bf16_f32 v58, v16, v17
  v_add_f32 v7, v16, v7
  v_mfma_f32_16x16x32_bf16 v[208:211], v[28:31], v[40:43], v[208:211]
  ds_read_b64_tr_b16 v[36:37], v1 offset:25184
  v_cvt_pk_bf16_f32 v59, v18, v19
  v_mfma_f32_16x16x32_bf16 a[156:159], v[32:35], v[40:43], a[156:159]
  s_waitcnt lgkmcnt(3)
  ds_read_b64_tr_b16 v[38:39], v1 offset:25696
  v_add_f32 v7, v17, v7
  v_mfma_f32_16x16x32_bf16 v[68:71], v[44:47], a[148:151], v[68:71]
  ds_read_b64_tr_b16 v[40:41], v1 offset:25200
  v_add_f32 v7, v18, v7
  v_mfma_f32_16x16x32_bf16 v[116:119], v[48:51], a[148:151], v[116:119]
  s_waitcnt lgkmcnt(3)
  ds_read_b64_tr_b16 v[42:43], v1 offset:25712
  v_add_f32 v7, v19, v7
  v_mfma_f32_16x16x32_bf16 v[164:167], v[52:55], a[148:151], v[164:167]
  s_lshr_b32 s42, s32, 1
  v_mbcnt_lo_u32_b32 v10, -1, 0
  v_mbcnt_hi_u32_b32 v10, -1, v10
  v_mfma_f32_16x16x32_bf16 v[212:215], v[56:59], a[148:151], v[212:215]
  s_mul_i32 s42, s42, 75456
  s_and_b32 s36, s32, 1
  ds_read_b64_tr_b16 a[148:149], v1 offset:29344
  v_mfma_f32_16x16x32_bf16 v[72:75], v[44:47], a[152:155], v[72:75]
  s_mul_i32 s36, s36, 12288
  ds_read_b64_tr_b16 a[150:151], v1 offset:29856
  v_mov_b32 v16, 1.0
  v_mfma_f32_16x16x32_bf16 v[120:123], v[48:51], a[152:155], v[120:123]
  s_add_u32 s42, s42, s36
  v_mov_b32 v2, 0
  v_mov_b32 v23, -1
  v_mfma_f32_16x16x32_bf16 v[168:171], v[52:55], a[152:155], v[168:171]
  s_add_u32 s42, s42, 25216
  v_mfma_f32_16x16x4_f32 v[24:27], v4, v16, 0
  v_mfma_f32_16x16x4_f32 v[28:31], v5, v16, 0
  v_mfma_f32_16x16x32_bf16 v[216:219], v[56:59], a[152:155], v[216:219]
  s_and_b32 s42, s42, 0xffffff80
  ds_read_b64_tr_b16 a[152:153], v1 offset:29360
  v_mfma_f32_16x16x4_f32 v[32:35], v6, v16, 0
  s_waitcnt lgkmcnt(5)
  v_mfma_f32_16x16x32_bf16 v[76:79], v[44:47], v[36:39], v[76:79]
  ds_read_b64_tr_b16 a[154:155], v1 offset:29872
  v_mfma_f32_16x16x4_f32 v[12:15], v7, v16, 0
  v_mfma_f32_16x16x32_bf16 v[124:127], v[48:51], v[36:39], v[124:127]
  v_and_b32 v11, 48, v10
  v_mul_u32_u24 v20, 96, v11
  v_mfma_f32_16x16x32_bf16 v[172:175], v[52:55], v[36:39], v[172:175]
  v_lshl_add_u32 v21, v11, 4, s42
  v_and_b32 v11, 7, v10
  v_mfma_f32_16x16x32_bf16 v[220:223], v[56:59], v[36:39], v[220:223]
  s_waitcnt lgkmcnt(4)
  ds_read_b64_tr_b16 v[36:37], v1 offset:29376
  v_lshl_add_u32 v20, v11, 4, v20
  v_mfma_f32_16x16x32_bf16 v[80:83], v[44:47], v[40:43], v[80:83]
  ds_read_b64_tr_b16 v[38:39], v1 offset:29888
  v_max3_u32 v2, v2, v24, v25
  v_mfma_f32_16x16x32_bf16 v[128:131], v[48:51], v[40:43], v[128:131]
  v_max3_u32 v2, v2, v26, v27
  v_min3_u32 v23, v23, v24, v25
  v_mfma_f32_16x16x32_bf16 v[176:179], v[52:55], v[40:43], v[176:179]
  v_min3_u32 v23, v23, v26, v27
  v_and_b32 v11, 8, v10
  v_mfma_f32_16x16x32_bf16 v[224:227], v[56:59], v[40:43], v[224:227]
  s_waitcnt lgkmcnt(4)
  ds_read_b64_tr_b16 v[40:41], v1 offset:29392
  v_add3_u32 v20, v20, v11, s42
  v_mfma_f32_16x16x32_bf16 v[84:87], v[44:47], a[148:151], v[84:87]
  ds_read_b64_tr_b16 v[42:43], v1 offset:29904
  v_and_b32 v11, 28, v10
  v_mfma_f32_16x16x32_bf16 v[132:135], v[48:51], a[148:151], v[132:135]
  v_rcp_f32 v24, v24
  v_mfma_f32_16x16x32_bf16 v[180:183], v[52:55], a[148:151], v[180:183]
  v_rcp_f32 v25, v25
  v_mfma_f32_16x16x32_bf16 v[228:231], v[56:59], a[148:151], v[228:231]
  s_waitcnt lgkmcnt(4)
  ds_read_b64_tr_b16 a[148:149], v1 offset:33536
  v_lshl_add_u32 v21, v11, 2, v21
  v_mfma_f32_16x16x32_bf16 v[88:91], v[44:47], a[152:155], v[88:91]
  ds_read_b64_tr_b16 a[150:151], v1 offset:34048
  v_and_b32 v11, 2, v10
  v_mfma_f32_16x16x32_bf16 v[136:139], v[48:51], a[152:155], v[136:139]
  v_rcp_f32 v26, v26
  v_mfma_f32_16x16x32_bf16 v[184:187], v[52:55], a[152:155], v[184:187]
  v_rcp_f32 v27, v27
  v_mfma_f32_16x16x32_bf16 v[232:235], v[56:59], a[152:155], v[232:235]
  s_waitcnt lgkmcnt(4)
  ds_read_b64_tr_b16 a[152:153], v1 offset:33552
  v_max3_u32 v2, v2, v28, v29
  v_mfma_f32_16x16x32_bf16 v[92:95], v[44:47], v[36:39], v[92:95]
  ds_read_b64_tr_b16 a[154:155], v1 offset:34064
  v_max3_u32 v2, v2, v30, v31
  v_mfma_f32_16x16x32_bf16 v[140:143], v[48:51], v[36:39], v[140:143]
  v_min3_u32 v23, v23, v28, v29
  v_min3_u32 v23, v23, v30, v31
  v_mfma_f32_16x16x32_bf16 v[188:191], v[52:55], v[36:39], v[188:191]
  v_rcp_f32 v28, v28
  v_mfma_f32_16x16x32_bf16 v[236:239], v[56:59], v[36:39], v[236:239]
  s_waitcnt lgkmcnt(4)
  ds_read_b64_tr_b16 v[36:37], v1 offset:33568
  v_lshl_add_u32 v21, v11, 6, v21
  v_mfma_f32_16x16x32_bf16 v[96:99], v[44:47], v[40:43], v[96:99]
  ds_read_b64_tr_b16 v[38:39], v1 offset:34080
  v_and_b32 v11, 1, v10
  v_mfma_f32_16x16x32_bf16 v[144:147], v[48:51], v[40:43], v[144:147]
  v_rcp_f32 v29, v29
  v_mfma_f32_16x16x32_bf16 v[192:195], v[52:55], v[40:43], v[192:195]
  s_waitcnt lgkmcnt(4)
  v_rcp_f32 v30, v30
  v_mfma_f32_16x16x32_bf16 v[240:243], v[56:59], v[40:43], v[240:243]
  s_mul_i32 s42, s32, 36864
  ds_read_b64_tr_b16 v[40:41], v1 offset:33584
  v_lshl_add_u32 v21, v11, 3, v21
  v_mfma_f32_16x16x32_bf16 v[100:103], v[44:47], a[148:151], v[100:103]
  s_mov_b32 s37, 0x45800000
  ds_read_b64_tr_b16 v[42:43], v1 offset:34096
  v_lshl_add_u32 v22, v10, 4, s42
  v_mfma_f32_16x16x32_bf16 v[148:151], v[48:51], a[148:151], v[148:151]
  s_mov_b32 s38, 0x35800000
  v_rcp_f32 v31, v31
  v_mfma_f32_16x16x32_bf16 v[196:199], v[52:55], a[148:151], v[196:199]
  v_max3_u32 v2, v2, v32, v33
  v_max3_u32 v2, v2, v34, v35
  v_mfma_f32_16x16x32_bf16 v[244:247], v[56:59], a[148:151], v[244:247]
  s_waitcnt lgkmcnt(4)
  v_min3_u32 v23, v23, v32, v33
  v_min3_u32 v23, v23, v34, v35
  v_mfma_f32_16x16x32_bf16 v[104:107], v[44:47], a[152:155], v[104:107]
  v_rcp_f32 v32, v32
  v_mfma_f32_16x16x32_bf16 v[152:155], v[48:51], a[152:155], v[152:155]
  v_rcp_f32 v33, v33
  v_mfma_f32_16x16x32_bf16 v[200:203], v[52:55], a[152:155], v[200:203]
  v_rcp_f32 v34, v34
  v_mfma_f32_16x16x32_bf16 v[248:251], v[56:59], a[152:155], v[248:251]
  s_waitcnt lgkmcnt(2)
  v_rcp_f32 v35, v35
  v_mfma_f32_16x16x32_bf16 v[108:111], v[44:47], v[36:39], v[108:111]
  v_max3_u32 v2, v2, v12, v13
  v_max3_u32 v2, v2, v14, v15
  v_mfma_f32_16x16x32_bf16 v[156:159], v[48:51], v[36:39], v[156:159]
  v_min3_u32 v23, v23, v12, v13
  v_min3_u32 v23, v23, v14, v15
  v_mfma_f32_16x16x32_bf16 v[204:207], v[52:55], v[36:39], v[204:207]
  v_rcp_f32 v12, v12
  v_mfma_f32_16x16x32_bf16 v[252:255], v[56:59], v[36:39], v[252:255]
  s_waitcnt lgkmcnt(0)
  v_rcp_f32 v13, v13
  v_mfma_f32_16x16x32_bf16 v[112:115], v[44:47], v[40:43], v[112:115]
  v_rcp_f32 v14, v14
  v_mfma_f32_16x16x32_bf16 v[160:163], v[48:51], v[40:43], v[160:163]
  v_rcp_f32 v15, v15
  v_mfma_f32_16x16x32_bf16 v[208:211], v[52:55], v[40:43], v[208:211]
  v_mfma_f32_16x16x32_bf16 a[156:159], v[56:59], v[40:43], a[156:159]
  v_xor_b32 v18, 64, v20
  v_xor_b32 v19, 64, v21
  v_pk_mul_f32 v[68:69], v[68:69], v[24:25]
  v_pk_mul_f32 v[70:71], v[70:71], v[26:27]
  v_pk_mul_f32 v[72:73], v[72:73], v[24:25]
  v_pk_mul_f32 v[74:75], v[74:75], v[26:27]
  v_pk_mul_f32 v[76:77], v[76:77], v[24:25]
  v_pk_mul_f32 v[78:79], v[78:79], v[26:27]
  v_pk_mul_f32 v[80:81], v[80:81], v[24:25]
  v_pk_mul_f32 v[82:83], v[82:83], v[26:27]
  v_cvt_pk_bf16_f32 v10, v68, v72
  v_cvt_pk_bf16_f32 v11, v76, v80
  ds_write_b64 v20, v[10:11] offset:0
  v_pk_mul_f32 v[84:85], v[84:85], v[24:25]
  v_pk_mul_f32 v[86:87], v[86:87], v[26:27]
  v_cvt_pk_bf16_f32 v68, v69, v73
  v_cvt_pk_bf16_f32 v69, v77, v81
  ds_write_b64 v18, v[68:69] offset:384
  v_pk_mul_f32 v[88:89], v[88:89], v[24:25]
  v_pk_mul_f32 v[90:91], v[90:91], v[26:27]
  v_cvt_pk_bf16_f32 v72, v70, v74
  v_cvt_pk_bf16_f32 v73, v78, v82
  ds_write_b64 v18, v[72:73] offset:768
  v_pk_mul_f32 v[92:93], v[92:93], v[24:25]
  v_pk_mul_f32 v[94:95], v[94:95], v[26:27]
  v_cvt_pk_bf16_f32 v70, v71, v75
  v_cvt_pk_bf16_f32 v71, v79, v83
  ds_write_b64 v20, v[70:71] offset:1152
  v_pk_mul_f32 v[96:97], v[96:97], v[24:25]
  v_pk_mul_f32 v[98:99], v[98:99], v[26:27]
  v_cvt_pk_bf16_f32 v10, v84, v88
  v_cvt_pk_bf16_f32 v11, v92, v96
  ds_write_b64 v20, v[10:11] offset:128
  v_pk_mul_f32 v[100:101], v[100:101], v[24:25]
  v_pk_mul_f32 v[102:103], v[102:103], v[26:27]
  v_cvt_pk_bf16_f32 v84, v85, v89
  v_cvt_pk_bf16_f32 v85, v93, v97
  ds_write_b64 v20, v[84:85] offset:512
  v_pk_mul_f32 v[104:105], v[104:105], v[24:25]
  v_pk_mul_f32 v[106:107], v[106:107], v[26:27]
  v_cvt_pk_bf16_f32 v88, v86, v90
  v_cvt_pk_bf16_f32 v89, v94, v98
  ds_write_b64 v18, v[88:89] offset:896
  v_pk_mul_f32 v[108:109], v[108:109], v[24:25]
  v_pk_mul_f32 v[110:111], v[110:111], v[26:27]
  v_cvt_pk_bf16_f32 v86, v87, v91
  v_cvt_pk_bf16_f32 v87, v95, v99
  ds_write_b64 v18, v[86:87] offset:1280
  v_pk_mul_f32 v[112:113], v[112:113], v[24:25]
  v_pk_mul_f32 v[114:115], v[114:115], v[26:27]
  v_cvt_pk_bf16_f32 v10, v100, v104
  v_cvt_pk_bf16_f32 v11, v108, v112
  ds_write_b64 v18, v[10:11] offset:256
  v_cvt_pk_bf16_f32 v100, v101, v105
  v_cvt_pk_bf16_f32 v101, v109, v113
  ds_write_b64 v20, v[100:101] offset:640
  v_cvt_pk_bf16_f32 v104, v102, v106
  v_cvt_pk_bf16_f32 v105, v110, v114
  ds_write_b64 v20, v[104:105] offset:1024
  v_cvt_pk_bf16_f32 v102, v103, v107
  v_cvt_pk_bf16_f32 v103, v111, v115
  ds_write_b64 v18, v[102:103] offset:1408
  ds_read_b64_tr_b16 v[68:69], v21 offset:0
  ds_read_b64_tr_b16 v[70:71], v19 offset:0
  ds_read_b64_tr_b16 v[72:73], v21 offset:1024
  ds_read_b64_tr_b16 v[74:75], v19 offset:1024
  ds_read_b64_tr_b16 v[76:77], v21 offset:2048
  ds_read_b64_tr_b16 v[78:79], v19 offset:2048
  ds_read_b64_tr_b16 v[80:81], v21 offset:3072
  ds_read_b64_tr_b16 v[82:83], v19 offset:3072
  ds_read_b64_tr_b16 v[84:85], v21 offset:4096
  ds_read_b64_tr_b16 v[86:87], v19 offset:4096
  ds_read_b64_tr_b16 v[88:89], v21 offset:5120
  ds_read_b64_tr_b16 v[90:91], v19 offset:5120
  v_pk_mul_f32 v[116:117], v[116:117], v[28:29]
  v_pk_mul_f32 v[118:119], v[118:119], v[30:31]
  v_pk_mul_f32 v[120:121], v[120:121], v[28:29]
  v_pk_mul_f32 v[122:123], v[122:123], v[30:31]
  v_pk_mul_f32 v[124:125], v[124:125], v[28:29]
  v_pk_mul_f32 v[126:127], v[126:127], v[30:31]
  v_pk_mul_f32 v[128:129], v[128:129], v[28:29]
  v_pk_mul_f32 v[130:131], v[130:131], v[30:31]
  v_cvt_pk_bf16_f32 v10, v116, v120
  v_cvt_pk_bf16_f32 v11, v124, v128
  ds_write_b64 v20, v[10:11] offset:6144
  v_pk_mul_f32 v[132:133], v[132:133], v[28:29]
  v_pk_mul_f32 v[134:135], v[134:135], v[30:31]
  v_cvt_pk_bf16_f32 v116, v117, v121
  v_cvt_pk_bf16_f32 v117, v125, v129
  ds_write_b64 v18, v[116:117] offset:6528
  v_pk_mul_f32 v[136:137], v[136:137], v[28:29]
  v_pk_mul_f32 v[138:139], v[138:139], v[30:31]
  v_cvt_pk_bf16_f32 v120, v118, v122
  v_cvt_pk_bf16_f32 v121, v126, v130
  ds_write_b64 v18, v[120:121] offset:6912
  s_mov_b32 s42, 0
  s_waitcnt lgkmcnt(13)
  buffer_store_dwordx4 v[68:71], v22, s[28:31], s42 offen offset:0 nt
  v_pk_mul_f32 v[140:141], v[140:141], v[28:29]
  v_pk_mul_f32 v[142:143], v[142:143], v[30:31]
  v_cvt_pk_bf16_f32 v118, v119, v123
  v_cvt_pk_bf16_f32 v119, v127, v131
  ds_write_b64 v20, v[118:119] offset:7296
  v_pk_mul_f32 v[144:145], v[144:145], v[28:29]
  v_pk_mul_f32 v[146:147], v[146:147], v[30:31]
  v_cvt_pk_bf16_f32 v10, v132, v136
  v_cvt_pk_bf16_f32 v11, v140, v144
  ds_write_b64 v20, v[10:11] offset:6272
  s_waitcnt lgkmcnt(13)
  buffer_store_dwordx4 v[72:75], v22, s[28:31], s42 offen offset:1024 nt
  v_pk_mul_f32 v[148:149], v[148:149], v[28:29]
  v_pk_mul_f32 v[150:151], v[150:151], v[30:31]
  v_cvt_pk_bf16_f32 v132, v133, v137
  v_cvt_pk_bf16_f32 v133, v141, v145
  ds_write_b64 v20, v[132:133] offset:6656
  v_pk_mul_f32 v[152:153], v[152:153], v[28:29]
  v_pk_mul_f32 v[154:155], v[154:155], v[30:31]
  v_cvt_pk_bf16_f32 v136, v134, v138
  v_cvt_pk_bf16_f32 v137, v142, v146
  ds_write_b64 v18, v[136:137] offset:7040
  s_waitcnt lgkmcnt(13)
  buffer_store_dwordx4 v[76:79], v22, s[28:31], s42 offen offset:2048 nt
  v_pk_mul_f32 v[156:157], v[156:157], v[28:29]
  v_pk_mul_f32 v[158:159], v[158:159], v[30:31]
  v_cvt_pk_bf16_f32 v134, v135, v139
  v_cvt_pk_bf16_f32 v135, v143, v147
  ds_write_b64 v18, v[134:135] offset:7424
  v_pk_mul_f32 v[160:161], v[160:161], v[28:29]
  v_pk_mul_f32 v[162:163], v[162:163], v[30:31]
  v_cvt_pk_bf16_f32 v10, v148, v152
  v_cvt_pk_bf16_f32 v11, v156, v160
  ds_write_b64 v18, v[10:11] offset:6400
  s_waitcnt lgkmcnt(13)
  buffer_store_dwordx4 v[80:83], v22, s[28:31], s42 offen offset:3072 nt
  v_cvt_pk_bf16_f32 v148, v149, v153
  v_cvt_pk_bf16_f32 v149, v157, v161
  ds_write_b64 v20, v[148:149] offset:6784
  v_cvt_pk_bf16_f32 v152, v150, v154
  v_cvt_pk_bf16_f32 v153, v158, v162
  ds_write_b64 v20, v[152:153] offset:7168
  s_mov_b32 s42, 4096
  s_waitcnt lgkmcnt(13)
  buffer_store_dwordx4 v[84:87], v22, s[28:31], s42 offen offset:0 nt
  v_cvt_pk_bf16_f32 v150, v151, v155
  v_cvt_pk_bf16_f32 v151, v159, v163
  ds_write_b64 v18, v[150:151] offset:7552
  ds_read_b64_tr_b16 v[116:117], v21 offset:6144
  ds_read_b64_tr_b16 v[118:119], v19 offset:6144
  ds_read_b64_tr_b16 v[120:121], v21 offset:7168
  ds_read_b64_tr_b16 v[122:123], v19 offset:7168
  ds_read_b64_tr_b16 v[124:125], v21 offset:8192
  ds_read_b64_tr_b16 v[126:127], v19 offset:8192
  ds_read_b64_tr_b16 v[128:129], v21 offset:9216
  ds_read_b64_tr_b16 v[130:131], v19 offset:9216
  ds_read_b64_tr_b16 v[132:133], v21 offset:10240
  ds_read_b64_tr_b16 v[134:135], v19 offset:10240
  ds_read_b64_tr_b16 v[136:137], v21 offset:11264
  ds_read_b64_tr_b16 v[138:139], v19 offset:11264
  v_pk_mul_f32 v[164:165], v[164:165], v[32:33]
  v_pk_mul_f32 v[166:167], v[166:167], v[34:35]
  v_pk_mul_f32 v[168:169], v[168:169], v[32:33]
  v_pk_mul_f32 v[170:171], v[170:171], v[34:35]
  v_pk_mul_f32 v[172:173], v[172:173], v[32:33]
  v_pk_mul_f32 v[174:175], v[174:175], v[34:35]
  v_pk_mul_f32 v[176:177], v[176:177], v[32:33]
  v_pk_mul_f32 v[178:179], v[178:179], v[34:35]
  v_cvt_pk_bf16_f32 v10, v164, v168
  v_cvt_pk_bf16_f32 v11, v172, v176
  ds_write_b64 v20, v[10:11] offset:0
  v_pk_mul_f32 v[180:181], v[180:181], v[32:33]
  v_pk_mul_f32 v[182:183], v[182:183], v[34:35]
  v_cvt_pk_bf16_f32 v164, v165, v169
  v_cvt_pk_bf16_f32 v165, v173, v177
  ds_write_b64 v18, v[164:165] offset:384
  v_pk_mul_f32 v[184:185], v[184:185], v[32:33]
  v_pk_mul_f32 v[186:187], v[186:187], v[34:35]
  v_cvt_pk_bf16_f32 v168, v166, v170
  v_cvt_pk_bf16_f32 v169, v174, v178
  ds_write_b64 v18, v[168:169] offset:768
  s_waitcnt lgkmcnt(15)
  buffer_store_dwordx4 v[88:91], v22, s[28:31], s42 offen offset:1024 nt
  v_pk_mul_f32 v[188:189], v[188:189], v[32:33]
  v_pk_mul_f32 v[190:191], v[190:191], v[34:35]
  v_cvt_pk_bf16_f32 v166, v167, v171
  v_cvt_pk_bf16_f32 v167, v175, v179
  ds_write_b64 v20, v[166:167] offset:1152
  v_pk_mul_f32 v[192:193], v[192:193], v[32:33]
  v_pk_mul_f32 v[194:195], v[194:195], v[34:35]
  v_cvt_pk_bf16_f32 v10, v180, v184
  v_cvt_pk_bf16_f32 v11, v188, v192
  ds_write_b64 v20, v[10:11] offset:128
  s_mov_b32 s42, 6144
  s_waitcnt lgkmcnt(15)
  buffer_store_dwordx4 v[116:119], v22, s[28:31], s42 offen offset:0 nt
  v_pk_mul_f32 v[196:197], v[196:197], v[32:33]
  v_pk_mul_f32 v[198:199], v[198:199], v[34:35]
  v_cvt_pk_bf16_f32 v180, v181, v185
  v_cvt_pk_bf16_f32 v181, v189, v193
  ds_write_b64 v20, v[180:181] offset:512
  v_pk_mul_f32 v[200:201], v[200:201], v[32:33]
  v_pk_mul_f32 v[202:203], v[202:203], v[34:35]
  v_cvt_pk_bf16_f32 v184, v182, v186
  v_cvt_pk_bf16_f32 v185, v190, v194
  ds_write_b64 v18, v[184:185] offset:896
  s_waitcnt lgkmcnt(15)
  buffer_store_dwordx4 v[120:123], v22, s[28:31], s42 offen offset:1024 nt
  v_pk_mul_f32 v[204:205], v[204:205], v[32:33]
  v_pk_mul_f32 v[206:207], v[206:207], v[34:35]
  v_cvt_pk_bf16_f32 v182, v183, v187
  v_cvt_pk_bf16_f32 v183, v191, v195
  ds_write_b64 v18, v[182:183] offset:1280
  v_pk_mul_f32 v[208:209], v[208:209], v[32:33]
  v_pk_mul_f32 v[210:211], v[210:211], v[34:35]
  v_cvt_pk_bf16_f32 v10, v196, v200
  v_cvt_pk_bf16_f32 v11, v204, v208
  ds_write_b64 v18, v[10:11] offset:256
  s_waitcnt lgkmcnt(15)
  buffer_store_dwordx4 v[124:127], v22, s[28:31], s42 offen offset:2048 nt
  v_cvt_pk_bf16_f32 v196, v197, v201
  v_cvt_pk_bf16_f32 v197, v205, v209
  ds_write_b64 v20, v[196:197] offset:640
  v_cvt_pk_bf16_f32 v200, v198, v202
  v_cvt_pk_bf16_f32 v201, v206, v210
  ds_write_b64 v20, v[200:201] offset:1024
  s_waitcnt lgkmcnt(15)
  buffer_store_dwordx4 v[128:131], v22, s[28:31], s42 offen offset:3072 nt
  v_cvt_pk_bf16_f32 v198, v199, v203
  v_cvt_pk_bf16_f32 v199, v207, v211
  ds_write_b64 v18, v[198:199] offset:1408
  ds_read_b64_tr_b16 v[164:165], v21 offset:0
  ds_read_b64_tr_b16 v[166:167], v19 offset:0
  ds_read_b64_tr_b16 v[168:169], v21 offset:1024
  ds_read_b64_tr_b16 v[170:171], v19 offset:1024
  ds_read_b64_tr_b16 v[172:173], v21 offset:2048
  ds_read_b64_tr_b16 v[174:175], v19 offset:2048
  ds_read_b64_tr_b16 v[176:177], v21 offset:3072
  ds_read_b64_tr_b16 v[178:179], v19 offset:3072
  ds_read_b64_tr_b16 v[180:181], v21 offset:4096
  ds_read_b64_tr_b16 v[182:183], v19 offset:4096
  ds_read_b64_tr_b16 v[184:185], v21 offset:5120
  ds_read_b64_tr_b16 v[186:187], v19 offset:5120
  ds_read_b128 a[124:127], v0 offset:0
  ds_read_b128 a[128:131], v0 offset:64
  ds_read_b128 a[132:135], v0 offset:4192
  ds_read_b128 a[136:139], v0 offset:4256
  ds_read_b128 a[140:143], v0 offset:8384
  ds_read_b128 a[144:147], v0 offset:8448
  ds_read_b128 a[120:123], v3 offset:4096
  ds_read_b64_tr_b16 a[148:149], v1 offset:0
  ds_read_b64_tr_b16 a[150:151], v1 offset:512
  ds_read_b64_tr_b16 a[152:153], v1 offset:16
  ds_read_b64_tr_b16 a[154:155], v1 offset:528
  ds_read_b64_tr_b16 a[0:1], v1 offset:32
  ds_read_b64_tr_b16 a[2:3], v1 offset:544
  ds_read_b64_tr_b16 a[4:5], v1 offset:48
  ds_read_b64_tr_b16 a[6:7], v1 offset:560
  v_pk_mul_f32 v[212:213], v[212:213], v[12:13]
  v_pk_mul_f32 v[214:215], v[214:215], v[14:15]
  v_pk_mul_f32 v[216:217], v[216:217], v[12:13]
  v_pk_mul_f32 v[218:219], v[218:219], v[14:15]
  v_pk_mul_f32 v[220:221], v[220:221], v[12:13]
  v_pk_mul_f32 v[222:223], v[222:223], v[14:15]
  v_pk_mul_f32 v[224:225], v[224:225], v[12:13]
  v_pk_mul_f32 v[226:227], v[226:227], v[14:15]
  v_cvt_pk_bf16_f32 v10, v212, v216
  v_cvt_pk_bf16_f32 v11, v220, v224
  ds_write_b64 v20, v[10:11] offset:6144
  v_pk_mul_f32 v[228:229], v[228:229], v[12:13]
  v_pk_mul_f32 v[230:231], v[230:231], v[14:15]
  v_cvt_pk_bf16_f32 v212, v213, v217
  v_cvt_pk_bf16_f32 v213, v221, v225
  ds_write_b64 v18, v[212:213] offset:6528
  v_pk_mul_f32 v[232:233], v[232:233], v[12:13]
  v_pk_mul_f32 v[234:235], v[234:235], v[14:15]
  v_cvt_pk_bf16_f32 v216, v214, v218
  v_cvt_pk_bf16_f32 v217, v222, v226
  ds_write_b64 v18, v[216:217] offset:6912
  s_mov_b32 s42, 10240
  s_waitcnt lgkmcnt(15)
  buffer_store_dwordx4 v[132:135], v22, s[28:31], s42 offen offset:0 nt
  v_pk_mul_f32 v[236:237], v[236:237], v[12:13]
  v_pk_mul_f32 v[238:239], v[238:239], v[14:15]
  v_cvt_pk_bf16_f32 v214, v215, v219
  v_cvt_pk_bf16_f32 v215, v223, v227
  ds_write_b64 v20, v[214:215] offset:7296
  v_pk_mul_f32 v[240:241], v[240:241], v[12:13]
  v_pk_mul_f32 v[242:243], v[242:243], v[14:15]
  v_cvt_pk_bf16_f32 v10, v228, v232
  v_cvt_pk_bf16_f32 v11, v236, v240
  ds_write_b64 v20, v[10:11] offset:6272
  buffer_store_dwordx4 v[136:139], v22, s[28:31], s42 offen offset:1024 nt
  v_pk_mul_f32 v[244:245], v[244:245], v[12:13]
  v_pk_mul_f32 v[246:247], v[246:247], v[14:15]
  v_cvt_pk_bf16_f32 v228, v229, v233
  v_cvt_pk_bf16_f32 v229, v237, v241
  ds_write_b64 v20, v[228:229] offset:6656
  v_pk_mul_f32 v[248:249], v[248:249], v[12:13]
  v_pk_mul_f32 v[250:251], v[250:251], v[14:15]
  v_cvt_pk_bf16_f32 v232, v230, v234
  v_cvt_pk_bf16_f32 v233, v238, v242
  ds_write_b64 v18, v[232:233] offset:7040
  s_mov_b32 s42, 12288
  buffer_store_dwordx4 v[164:167], v22, s[28:31], s42 offen offset:0 nt
  v_pk_mul_f32 v[252:253], v[252:253], v[12:13]
  v_pk_mul_f32 v[254:255], v[254:255], v[14:15]
  v_cvt_pk_bf16_f32 v230, v231, v235
  v_cvt_pk_bf16_f32 v231, v239, v243
  ds_write_b64 v18, v[230:231] offset:7424
  v_accvgpr_read_b32 v104, a156
  v_accvgpr_read_b32 v105, a157
  v_accvgpr_read_b32 v106, a158
  v_accvgpr_read_b32 v107, a159
  v_pk_mul_f32 v[104:105], v[104:105], v[12:13]
  v_pk_mul_f32 v[106:107], v[106:107], v[14:15]
  v_cvt_pk_bf16_f32 v10, v244, v248
  v_cvt_pk_bf16_f32 v11, v252, v104
  ds_write_b64 v18, v[10:11] offset:6400
  buffer_store_dwordx4 v[168:171], v22, s[28:31], s42 offen offset:1024 nt
  v_cvt_pk_bf16_f32 v244, v245, v249
  v_cvt_pk_bf16_f32 v245, v253, v105
  ds_write_b64 v20, v[244:245] offset:6784
  v_cvt_pk_bf16_f32 v248, v246, v250
  v_cvt_pk_bf16_f32 v249, v254, v106
  ds_write_b64 v20, v[248:249] offset:7168
  buffer_store_dwordx4 v[172:175], v22, s[28:31], s42 offen offset:2048 nt
  v_cvt_pk_bf16_f32 v246, v247, v251
  v_cvt_pk_bf16_f32 v247, v255, v107
  ds_write_b64 v18, v[246:247] offset:7552
  ds_read_b64_tr_b16 v[212:213], v21 offset:6144
  ds_read_b64_tr_b16 v[214:215], v19 offset:6144
  ds_read_b64_tr_b16 v[216:217], v21 offset:7168
  ds_read_b64_tr_b16 v[218:219], v19 offset:7168
  ds_read_b64_tr_b16 v[220:221], v21 offset:8192
  ds_read_b64_tr_b16 v[222:223], v19 offset:8192
  ds_read_b64_tr_b16 v[224:225], v21 offset:9216
  ds_read_b64_tr_b16 v[226:227], v19 offset:9216
  ds_read_b64_tr_b16 v[228:229], v21 offset:10240
  ds_read_b64_tr_b16 v[230:231], v19 offset:10240
  ds_read_b64_tr_b16 v[232:233], v21 offset:11264
  ds_read_b64_tr_b16 v[234:235], v19 offset:11264
  v_mfma_f32_16x16x32_bf16 v[12:15], a[124:127], a[80:83], -4.0
  v_mfma_f32_16x16x32_bf16 v[12:15], a[128:131], a[84:87], v[12:15]
  v_mfma_f32_16x16x32_bf16 v[12:15], a[132:135], a[88:91], v[12:15]
  s_waitcnt lgkmcnt(15)
  v_mfma_f32_16x16x32_bf16 v[12:15], a[136:139], a[92:95], v[12:15]
  v_mfma_f32_16x16x32_bf16 v[12:15], a[140:143], a[96:99], v[12:15]
  buffer_store_dwordx4 v[176:179], v22, s[28:31], s42 offen offset:3072 nt
  v_mfma_f32_16x16x32_bf16 v[12:15], a[144:147], a[120:123], v[12:15]
  ds_read_b128 a[120:123], v3 offset:5120
  v_mfma_f32_16x16x32_bf16 a[160:163], v[60:63], a[148:151], a[160:163]
  v_mfma_f32_16x16x32_bf16 a[208:211], v[64:67], a[148:151], a[208:211]
  ds_read_b64_tr_b16 a[148:149], v1 offset:4192
  v_mfma_f32_16x16x32_bf16 a[164:167], v[60:63], a[152:155], a[164:167]
  ds_read_b64_tr_b16 a[150:151], v1 offset:4704
  v_mfma_f32_16x16x32_bf16 a[212:215], v[64:67], a[152:155], a[212:215]
  ds_read_b64_tr_b16 a[152:153], v1 offset:4208
  v_mfma_f32_16x16x32_bf16 a[168:171], v[60:63], a[0:3], a[168:171]
  ds_read_b64_tr_b16 a[154:155], v1 offset:4720
  v_mfma_f32_16x16x32_bf16 a[216:219], v[64:67], a[0:3], a[216:219]
  v_exp_f32 v12, v12
  v_mfma_f32_16x16x32_bf16 v[16:19], a[124:127], a[100:103], -4.0
  ds_read_b128 a[124:127], v0 offset:512
  v_mfma_f32_16x16x32_bf16 v[16:19], a[128:131], a[104:107], v[16:19]
  s_mov_b32 s42, 16384
  buffer_store_dwordx4 v[180:183], v22, s[28:31], s42 offen offset:0 nt
  v_mfma_f32_16x16x32_bf16 v[16:19], a[132:135], a[108:111], v[16:19]
  ds_read_b128 a[128:131], v0 offset:576
  v_mfma_f32_16x16x32_bf16 v[16:19], a[136:139], a[112:115], v[16:19]
  v_exp_f32 v13, v13
  v_mfma_f32_16x16x32_bf16 v[16:19], a[140:143], a[116:119], v[16:19]
  s_waitcnt lgkmcnt(6)
  ds_read_b128 a[132:135], v0 offset:4704
  v_mfma_f32_16x16x32_bf16 v[16:19], a[144:147], a[120:123], v[16:19]
  v_exp_f32 v14, v14
  v_mfma_f32_16x16x32_bf16 a[172:175], v[60:63], a[4:7], a[172:175]
  v_exp_f32 v15, v15
  v_mfma_f32_16x16x32_bf16 a[220:223], v[64:67], a[4:7], a[220:223]
  s_waitcnt lgkmcnt(5)
  ds_read_b128 a[136:139], v0 offset:4768
  v_cvt_pk_bf16_f32 v36, v12, v13
  v_mfma_f32_16x16x32_bf16 a[176:179], v[60:63], a[148:151], a[176:179]
  ds_read_b128 a[140:143], v0 offset:8896
  v_add_f32 v8, v12, v8
  v_mfma_f32_16x16x32_bf16 a[224:227], v[64:67], a[148:151], a[224:227]
  s_waitcnt lgkmcnt(5)
  v_cvt_pk_bf16_f32 v37, v14, v15
  v_add_f32 v8, v13, v8
  v_mfma_f32_16x16x32_bf16 a[180:183], v[60:63], a[152:155], a[180:183]
  ds_read_b128 a[144:147], v0 offset:8960
  ds_read_b128 a[120:123], v3 offset:4096
  buffer_store_dwordx4 v[184:187], v22, s[28:31], s42 offen offset:1024 nt
  v_mfma_f32_16x16x32_bf16 a[228:231], v[64:67], a[152:155], a[228:231]
  s_waitcnt lgkmcnt(6)
  ds_read_b64_tr_b16 a[0:1], v1 offset:4224
  ds_read_b64_tr_b16 a[2:3], v1 offset:4736
  v_add_f32 v8, v14, v8
  v_add_f32 v8, v15, v8
  v_mfma_f32_16x16x32_bf16 v[12:15], a[124:127], a[80:83], -4.0
  s_waitcnt lgkmcnt(7)
  ds_read_b64_tr_b16 a[4:5], v1 offset:4240
  v_mfma_f32_16x16x32_bf16 v[12:15], a[128:131], a[84:87], v[12:15]
  s_waitcnt lgkmcnt(7)
  ds_read_b64_tr_b16 a[6:7], v1 offset:4752
  v_mfma_f32_16x16x32_bf16 v[12:15], a[132:135], a[88:91], v[12:15]
  s_waitcnt lgkmcnt(7)
  ds_read_b64_tr_b16 a[148:149], v1 offset:8384
  v_mfma_f32_16x16x32_bf16 v[12:15], a[136:139], a[92:95], v[12:15]
  s_waitcnt lgkmcnt(7)
  ds_read_b64_tr_b16 a[150:151], v1 offset:8896
  v_mfma_f32_16x16x32_bf16 v[12:15], a[140:143], a[96:99], v[12:15]
  s_waitcnt lgkmcnt(6)
  v_exp_f32 v16, v16
  v_mfma_f32_16x16x32_bf16 v[12:15], a[144:147], a[120:123], v[12:15]
  s_waitcnt lgkmcnt(4)
  v_exp_f32 v17, v17
  v_mfma_f32_16x16x32_bf16 a[184:187], v[60:63], a[0:3], a[184:187]
  s_waitcnt lgkmcnt(2)
  v_exp_f32 v18, v18
  v_mfma_f32_16x16x32_bf16 a[232:235], v[64:67], a[0:3], a[232:235]
  s_mov_b32 s42, 18432
  buffer_store_dwordx4 v[212:215], v22, s[28:31], s42 offen offset:0 nt
  v_mfma_f32_16x16x32_bf16 a[188:191], v[60:63], a[4:7], a[188:191]
  v_exp_f32 v19, v19
  v_mfma_f32_16x16x32_bf16 a[236:239], v[64:67], a[4:7], a[236:239]
  s_waitcnt lgkmcnt(0)
  v_cvt_pk_bf16_f32 v40, v16, v17
  v_add_f32 v9, v16, v9
  v_mfma_f32_16x16x32_bf16 a[192:195], v[60:63], a[148:151], a[192:195]
  ds_read_b128 a[120:123], v3 offset:5120
  v_cvt_pk_bf16_f32 v41, v18, v19
  v_add_f32 v9, v17, v9
  v_mfma_f32_16x16x32_bf16 a[240:243], v[64:67], a[148:151], a[240:243]
  ds_read_b64_tr_b16 a[152:153], v1 offset:8400
  ds_read_b64_tr_b16 a[154:155], v1 offset:8912
  v_add_f32 v9, v18, v9
  v_add_f32 v9, v19, v9
  v_mfma_f32_16x16x32_bf16 v[16:19], a[124:127], a[100:103], -4.0
  ds_read_b64_tr_b16 a[0:1], v1 offset:8416
  v_mfma_f32_16x16x32_bf16 v[16:19], a[128:131], a[104:107], v[16:19]
  ds_read_b64_tr_b16 a[2:3], v1 offset:8928
  v_mfma_f32_16x16x32_bf16 v[16:19], a[132:135], a[108:111], v[16:19]
  ds_read_b64_tr_b16 a[4:5], v1 offset:8432
  v_mfma_f32_16x16x32_bf16 v[16:19], a[136:139], a[112:115], v[16:19]
  ds_read_b64_tr_b16 a[6:7], v1 offset:8944
  v_mfma_f32_16x16x32_bf16 v[16:19], a[140:143], a[116:119], v[16:19]
  s_waitcnt lgkmcnt(6)
  buffer_store_dwordx4 v[216:219], v22, s[28:31], s42 offen offset:1024 nt
  v_mfma_f32_16x16x32_bf16 v[16:19], a[144:147], a[120:123], v[16:19]
  s_waitcnt lgkmcnt(4)
  ds_read_b128 a[124:127], v0 offset:12576
  v_mfma_f32_16x16x32_bf16 a[196:199], v[60:63], a[152:155], a[196:199]
  ds_read_b128 a[128:131], v0 offset:12640
  v_mfma_f32_16x16x32_bf16 a[244:247], v[64:67], a[152:155], a[244:247]
  s_waitcnt lgkmcnt(4)
  ds_read_b128 a[132:135], v0 offset:16768
  v_exp_f32 v12, v12
  v_exp_f32 v13, v13
  v_mfma_f32_16x16x32_bf16 a[200:203], v[60:63], a[0:3], a[200:203]
  ds_read_b128 a[136:139], v0 offset:16832
  v_exp_f32 v14, v14
  v_exp_f32 v15, v15
  v_mfma_f32_16x16x32_bf16 a[248:251], v[64:67], a[0:3], a[248:251]
  s_waitcnt lgkmcnt(4)
  ds_read_b128 a[140:143], v0 offset:20960
  v_cvt_pk_bf16_f32 v38, v12, v13
  v_add_f32 v8, v12, v8
  v_mfma_f32_16x16x32_bf16 a[204:207], v[60:63], a[4:7], a[204:207]
  ds_read_b128 a[144:147], v0 offset:21024
  ds_read_b128 a[120:123], v3 offset:4096
  v_cvt_pk_bf16_f32 v39, v14, v15
  v_add_f32 v8, v13, v8
  v_mfma_f32_16x16x32_bf16 a[252:255], v[64:67], a[4:7], a[252:255]
  s_waitcnt lgkmcnt(6)
  ds_read_b64_tr_b16 a[148:149], v1 offset:12576
  ds_read_b64_tr_b16 a[150:151], v1 offset:13088
  v_add_f32 v8, v14, v8
  v_add_f32 v8, v15, v8
  v_mfma_f32_16x16x32_bf16 v[12:15], a[124:127], a[80:83], -4.0
  s_waitcnt lgkmcnt(7)
  v_exp_f32 v16, v16
  v_mfma_f32_16x16x32_bf16 v[12:15], a[128:131], a[84:87], v[12:15]
  s_waitcnt lgkmcnt(6)
  ds_read_b64_tr_b16 a[152:153], v1 offset:12592
  ds_read_b64_tr_b16 a[154:155], v1 offset:13104
  buffer_store_dwordx4 v[220:223], v22, s[28:31], s42 offen offset:2048 nt
  v_exp_f32 v17, v17
  v_mfma_f32_16x16x32_bf16 v[12:15], a[132:135], a[88:91], v[12:15]
  s_waitcnt lgkmcnt(7)
  v_exp_f32 v18, v18
  v_exp_f32 v19, v19
  v_mfma_f32_16x16x32_bf16 v[12:15], a[136:139], a[92:95], v[12:15]
  s_waitcnt lgkmcnt(6)
  ds_read_b64_tr_b16 a[0:1], v1 offset:12608
  ds_read_b64_tr_b16 a[2:3], v1 offset:13120
  v_cvt_pk_bf16_f32 v42, v16, v17
  v_add_f32 v9, v16, v9
  v_mfma_f32_16x16x32_bf16 v[12:15], a[140:143], a[96:99], v[12:15]
  s_waitcnt lgkmcnt(6)
  v_cvt_pk_bf16_f32 v43, v18, v19
  v_add_f32 v9, v17, v9
  v_mfma_f32_16x16x32_bf16 v[12:15], a[144:147], a[120:123], v[12:15]
  s_waitcnt lgkmcnt(4)
  v_add_f32 v9, v18, v9
  v_add_f32 v9, v19, v9
  v_mfma_f32_16x16x32_bf16 a[160:163], v[36:39], a[148:151], a[160:163]
  ds_read_b128 a[120:123], v3 offset:5120
  v_mfma_f32_16x16x32_bf16 a[208:211], v[40:43], a[148:151], a[208:211]
  s_waitcnt lgkmcnt(3)
  ds_read_b64_tr_b16 a[4:5], v1 offset:12624
  v_mfma_f32_16x16x32_bf16 a[164:167], v[36:39], a[152:155], a[164:167]
  ds_read_b64_tr_b16 a[6:7], v1 offset:13136
  v_mfma_f32_16x16x32_bf16 a[212:215], v[40:43], a[152:155], a[212:215]
  s_waitcnt lgkmcnt(3)
  ds_read_b64_tr_b16 a[148:149], v1 offset:16768
  v_mfma_f32_16x16x32_bf16 a[168:171], v[36:39], a[0:3], a[168:171]
  buffer_store_dwordx4 v[224:227], v22, s[28:31], s42 offen offset:3072 nt
  v_mfma_f32_16x16x32_bf16 a[216:219], v[40:43], a[0:3], a[216:219]
  ds_read_b64_tr_b16 a[150:151], v1 offset:17280
  v_mfma_f32_16x16x32_bf16 v[16:19], a[124:127], a[100:103], -4.0
  ds_read_b128 a[124:127], v0 offset:13088
  v_mfma_f32_16x16x32_bf16 v[16:19], a[128:131], a[104:107], v[16:19]
  ds_read_b128 a[128:131], v0 offset:13152
  v_mfma_f32_16x16x32_bf16 v[16:19], a[132:135], a[108:111], v[16:19]
  v_exp_f32 v12, v12
  v_mfma_f32_16x16x32_bf16 v[16:19], a[136:139], a[112:115], v[16:19]
  v_exp_f32 v13, v13
  v_mfma_f32_16x16x32_bf16 v[16:19], a[140:143], a[116:119], v[16:19]
  s_waitcnt lgkmcnt(6)
  ds_read_b128 a[132:135], v0 offset:17280
  v_mfma_f32_16x16x32_bf16 v[16:19], a[144:147], a[120:123], v[16:19]
  s_waitcnt lgkmcnt(5)
  v_exp_f32 v14, v14
  v_mfma_f32_16x16x32_bf16 a[172:175], v[36:39], a[4:7], a[172:175]
  s_waitcnt lgkmcnt(3)
  ds_read_b128 a[136:139], v0 offset:17344
  v_exp_f32 v15, v15
  v_mfma_f32_16x16x32_bf16 a[220:223], v[40:43], a[4:7], a[220:223]
  s_mov_b32 s42, 22528
  ds_read_b128 a[140:143], v0 offset:21472
  buffer_store_dwordx4 v[228:231], v22, s[28:31], s42 offen offset:0 nt
  v_cvt_pk_bf16_f32 v60, v12, v13
  v_add_f32 v8, v12, v8
  v_mfma_f32_16x16x32_bf16 a[176:179], v[36:39], a[148:151], a[176:179]
  ds_read_b128 a[144:147], v0 offset:21536
  ds_read_b128 a[120:123], v3 offset:4096
  v_cvt_pk_bf16_f32 v61, v14, v15
  v_add_f32 v8, v13, v8
  v_mfma_f32_16x16x32_bf16 a[224:227], v[40:43], a[148:151], a[224:227]
  s_waitcnt lgkmcnt(6)
  ds_read_b64_tr_b16 a[152:153], v1 offset:16784
  ds_read_b64_tr_b16 a[154:155], v1 offset:17296
  v_add_f32 v8, v14, v8
  v_add_f32 v8, v15, v8
  v_mfma_f32_16x16x32_bf16 v[12:15], a[124:127], a[80:83], -4.0
  s_waitcnt lgkmcnt(7)
  ds_read_b64_tr_b16 a[0:1], v1 offset:16800
  v_mfma_f32_16x16x32_bf16 v[12:15], a[128:131], a[84:87], v[12:15]
  s_waitcnt lgkmcnt(7)
  ds_read_b64_tr_b16 a[2:3], v1 offset:17312
  v_mfma_f32_16x16x32_bf16 v[12:15], a[132:135], a[88:91], v[12:15]
  s_waitcnt lgkmcnt(7)
  v_exp_f32 v16, v16
  v_mfma_f32_16x16x32_bf16 v[12:15], a[136:139], a[92:95], v[12:15]
  s_waitcnt lgkmcnt(6)
  v_exp_f32 v17, v17
  v_mfma_f32_16x16x32_bf16 v[12:15], a[140:143], a[96:99], v[12:15]
  s_waitcnt lgkmcnt(4)
  v_exp_f32 v18, v18
  v_mfma_f32_16x16x32_bf16 v[12:15], a[144:147], a[120:123], v[12:15]
  s_waitcnt lgkmcnt(2)
  v_exp_f32 v19, v19
  v_mfma_f32_16x16x32_bf16 a[180:183], v[36:39], a[152:155], a[180:183]
  buffer_store_dwordx4 v[232:235], v22, s[28:31], s42 offen offset:1024 nt
  v_mfma_f32_16x16x32_bf16 a[228:231], v[40:43], a[152:155], a[228:231]
  s_waitcnt lgkmcnt(0)
  v_cvt_pk_bf16_f32 v64, v16, v17
  v_add_f32 v9, v16, v9
  v_mfma_f32_16x16x32_bf16 a[184:187], v[36:39], a[0:3], a[184:187]
  ds_read_b128 a[120:123], v3 offset:5120
  v_cvt_pk_bf16_f32 v65, v18, v19
  v_add_f32 v9, v17, v9
  v_mfma_f32_16x16x32_bf16 a[232:235], v[40:43], a[0:3], a[232:235]
  ds_read_b64_tr_b16 a[4:5], v1 offset:16816
  ds_read_b64_tr_b16 a[6:7], v1 offset:17328
  v_add_f32 v9, v18, v9
  v_add_f32 v9, v19, v9
  v_mfma_f32_16x16x32_bf16 v[16:19], a[124:127], a[100:103], -4.0
  ds_read_b64_tr_b16 a[148:149], v1 offset:20960
  v_mfma_f32_16x16x32_bf16 v[16:19], a[128:131], a[104:107], v[16:19]
  ds_read_b64_tr_b16 a[150:151], v1 offset:21472
  v_mfma_f32_16x16x32_bf16 v[16:19], a[132:135], a[108:111], v[16:19]
  ds_read_b64_tr_b16 a[152:153], v1 offset:20976
  v_mfma_f32_16x16x32_bf16 v[16:19], a[136:139], a[112:115], v[16:19]
  ds_read_b64_tr_b16 a[154:155], v1 offset:21488
  v_mfma_f32_16x16x32_bf16 v[16:19], a[140:143], a[116:119], v[16:19]
  s_waitcnt lgkmcnt(6)
  ds_read_b64_tr_b16 a[0:1], v1 offset:20992
  v_mfma_f32_16x16x32_bf16 v[16:19], a[144:147], a[120:123], v[16:19]
  s_waitcnt lgkmcnt(5)
  ds_read_b64_tr_b16 a[2:3], v1 offset:21504
  v_mfma_f32_16x16x32_bf16 a[188:191], v[36:39], a[4:7], a[188:191]
  v_exp_f32 v12, v12
  v_mfma_f32_16x16x32_bf16 a[236:239], v[40:43], a[4:7], a[236:239]
  s_waitcnt lgkmcnt(4)
  ds_read_b64_tr_b16 a[4:5], v1 offset:21008
  ds_read_b64_tr_b16 a[6:7], v1 offset:21520
  v_mfma_f32_16x16x32_bf16 a[192:195], v[36:39], a[148:151], a[192:195]
  v_exp_f32 v13, v13
  v_mfma_f32_16x16x32_bf16 a[240:243], v[40:43], a[148:151], a[240:243]
  s_waitcnt lgkmcnt(4)
  ds_read_b64_tr_b16 a[148:149], v1 offset:25152
  ds_read_b64_tr_b16 a[150:151], v1 offset:25664
  v_mfma_f32_16x16x32_bf16 a[196:199], v[36:39], a[152:155], a[196:199]
  v_exp_f32 v14, v14
  v_mfma_f32_16x16x32_bf16 a[244:247], v[40:43], a[152:155], a[244:247]
  s_waitcnt lgkmcnt(4)
  ds_read_b64_tr_b16 a[152:153], v1 offset:25168
  ds_read_b64_tr_b16 a[154:155], v1 offset:25680
  v_exp_f32 v15, v15
  v_cvt_pk_bf16_f32 v62, v12, v13
  v_add_f32 v8, v12, v8
  v_cvt_pk_bf16_f32 v63, v14, v15
  v_add_f32 v8, v13, v8
  v_add_f32 v8, v14, v8
  v_add_f32 v8, v15, v8
  v_exp_f32 v16, v16
  v_exp_f32 v17, v17
  v_mfma_f32_16x16x32_bf16 a[200:203], v[36:39], a[0:3], a[200:203]
  v_exp_f32 v18, v18
  v_exp_f32 v19, v19
  v_mfma_f32_16x16x32_bf16 a[248:251], v[40:43], a[0:3], a[248:251]
  s_waitcnt lgkmcnt(4)
  ds_read_b64_tr_b16 a[0:1], v1 offset:25184
  ds_read_b64_tr_b16 a[2:3], v1 offset:25696
  v_cvt_pk_bf16_f32 v66, v16, v17
  v_add_f32 v9, v16, v9
  v_mfma_f32_16x16x32_bf16 a[204:207], v[36:39], a[4:7], a[204:207]
  v_cvt_pk_bf16_f32 v67, v18, v19
  v_add_f32 v9, v17, v9
  v_mfma_f32_16x16x32_bf16 a[252:255], v[40:43], a[4:7], a[252:255]
  s_waitcnt lgkmcnt(4)
  ds_read_b64_tr_b16 a[4:5], v1 offset:25200
  ds_read_b64_tr_b16 a[6:7], v1 offset:25712
  v_mfma_f32_16x16x32_bf16 a[160:163], v[60:63], a[148:151], a[160:163]
  v_add_f32 v9, v18, v9
  v_add_f32 v9, v19, v9
  v_mfma_f32_16x16x32_bf16 a[208:211], v[64:67], a[148:151], a[208:211]
  s_waitcnt lgkmcnt(4)
  ds_read_b64_tr_b16 a[148:149], v1 offset:29344
  ds_read_b64_tr_b16 a[150:151], v1 offset:29856
  v_mfma_f32_16x16x32_bf16 a[164:167], v[60:63], a[152:155], a[164:167]
  v_mov_b32 v16, 1.0
  s_nop 1
  v_mfma_f32_16x16x4_f32 v[24:27], v8, v16, 0
  v_mfma_f32_16x16x32_bf16 a[212:215], v[64:67], a[152:155], a[212:215]
  s_waitcnt lgkmcnt(4)
  ds_read_b64_tr_b16 a[152:153], v1 offset:29360
  ds_read_b64_tr_b16 a[154:155], v1 offset:29872
  v_mfma_f32_16x16x32_bf16 a[168:171], v[60:63], a[0:3], a[168:171]
  v_mfma_f32_16x16x4_f32 v[28:31], v9, v16, 0
  v_mfma_f32_16x16x32_bf16 a[216:219], v[64:67], a[0:3], a[216:219]
  s_waitcnt lgkmcnt(4)
  ds_read_b64_tr_b16 a[0:1], v1 offset:29376
  ds_read_b64_tr_b16 a[2:3], v1 offset:29888
  v_mfma_f32_16x16x32_bf16 a[172:175], v[60:63], a[4:7], a[172:175]
  v_mfma_f32_16x16x32_bf16 a[220:223], v[64:67], a[4:7], a[220:223]
  s_waitcnt lgkmcnt(4)
  ds_read_b64_tr_b16 a[4:5], v1 offset:29392
  ds_read_b64_tr_b16 a[6:7], v1 offset:29904
  v_mfma_f32_16x16x32_bf16 a[176:179], v[60:63], a[148:151], a[176:179]
  v_mfma_f32_16x16x32_bf16 a[224:227], v[64:67], a[148:151], a[224:227]
  s_waitcnt lgkmcnt(4)
  ds_read_b64_tr_b16 a[148:149], v1 offset:33536
  ds_read_b64_tr_b16 a[150:151], v1 offset:34048
  v_mfma_f32_16x16x32_bf16 a[180:183], v[60:63], a[152:155], a[180:183]
  v_max3_u32 v2, v2, v24, v25
  v_max3_u32 v2, v2, v26, v27
  v_mfma_f32_16x16x32_bf16 a[228:231], v[64:67], a[152:155], a[228:231]
  s_waitcnt lgkmcnt(4)
  ds_read_b64_tr_b16 a[152:153], v1 offset:33552
  ds_read_b64_tr_b16 a[154:155], v1 offset:34064
  v_mfma_f32_16x16x32_bf16 a[184:187], v[60:63], a[0:3], a[184:187]
  v_min3_u32 v23, v23, v24, v25
  v_min3_u32 v23, v23, v26, v27
  v_mfma_f32_16x16x32_bf16 a[232:235], v[64:67], a[0:3], a[232:235]
  s_waitcnt lgkmcnt(4)
  ds_read_b64_tr_b16 a[0:1], v1 offset:33568
  ds_read_b64_tr_b16 a[2:3], v1 offset:34080
  v_mfma_f32_16x16x32_bf16 a[188:191], v[60:63], a[4:7], a[188:191]
  v_rcp_f32 v24, v24
  v_mfma_f32_16x16x32_bf16 a[236:239], v[64:67], a[4:7], a[236:239]
  s_waitcnt lgkmcnt(4)
  ds_read_b64_tr_b16 a[4:5], v1 offset:33584
  ds_read_b64_tr_b16 a[6:7], v1 offset:34096
  v_mfma_f32_16x16x32_bf16 a[192:195], v[60:63], a[148:151], a[192:195]
  v_rcp_f32 v25, v25
  v_mfma_f32_16x16x32_bf16 a[240:243], v[64:67], a[148:151], a[240:243]
  s_waitcnt lgkmcnt(4)
  v_rcp_f32 v26, v26
  v_mfma_f32_16x16x32_bf16 a[196:199], v[60:63], a[152:155], a[196:199]
  v_rcp_f32 v27, v27
  v_mfma_f32_16x16x32_bf16 a[244:247], v[64:67], a[152:155], a[244:247]
  s_waitcnt lgkmcnt(2)
  v_max3_u32 v2, v2, v28, v29
  v_max3_u32 v2, v2, v30, v31
  v_mfma_f32_16x16x32_bf16 a[200:203], v[60:63], a[0:3], a[200:203]
  v_min3_u32 v23, v23, v28, v29
  v_min3_u32 v23, v23, v30, v31
  v_mfma_f32_16x16x32_bf16 a[248:251], v[64:67], a[0:3], a[248:251]
  s_waitcnt lgkmcnt(0)
  v_rcp_f32 v28, v28
  v_mfma_f32_16x16x32_bf16 a[204:207], v[60:63], a[4:7], a[204:207]
  v_rcp_f32 v29, v29
  v_mfma_f32_16x16x32_bf16 a[252:255], v[64:67], a[4:7], a[252:255]
  v_rcp_f32 v30, v30
  v_rcp_f32 v31, v31
  v_xor_b32 v18, 64, v20
  v_xor_b32 v19, 64, v21
  v_accvgpr_read_b32 v92, a160
  v_accvgpr_read_b32 v93, a161
  v_accvgpr_read_b32 v94, a162
  v_accvgpr_read_b32 v95, a163
  v_pk_mul_f32 v[92:93], v[92:93], v[24:25]
  v_pk_mul_f32 v[94:95], v[94:95], v[26:27]
  v_accvgpr_read_b32 v96, a164
  v_accvgpr_read_b32 v97, a165
  v_accvgpr_read_b32 v98, a166
  v_accvgpr_read_b32 v99, a167
  v_pk_mul_f32 v[96:97], v[96:97], v[24:25]
  v_pk_mul_f32 v[98:99], v[98:99], v[26:27]
  v_accvgpr_read_b32 v100, a168
  v_accvgpr_read_b32 v101, a169
  v_accvgpr_read_b32 v102, a170
  v_accvgpr_read_b32 v103, a171
  v_pk_mul_f32 v[100:101], v[100:101], v[24:25]
  v_pk_mul_f32 v[102:103], v[102:103], v[26:27]
  v_accvgpr_read_b32 v104, a172
  v_accvgpr_read_b32 v105, a173
  v_accvgpr_read_b32 v106, a174
  v_accvgpr_read_b32 v107, a175
  v_pk_mul_f32 v[104:105], v[104:105], v[24:25]
  v_pk_mul_f32 v[106:107], v[106:107], v[26:27]
  v_cvt_pk_bf16_f32 v10, v92, v96
  v_cvt_pk_bf16_f32 v11, v100, v104
  ds_write_b64 v20, v[10:11] offset:0
  v_accvgpr_read_b32 v108, a176
  v_accvgpr_read_b32 v109, a177
  v_accvgpr_read_b32 v110, a178
  v_accvgpr_read_b32 v111, a179
  v_pk_mul_f32 v[108:109], v[108:109], v[24:25]
  v_pk_mul_f32 v[110:111], v[110:111], v[26:27]
  v_cvt_pk_bf16_f32 v92, v93, v97
  v_cvt_pk_bf16_f32 v93, v101, v105
  ds_write_b64 v18, v[92:93] offset:384
  v_accvgpr_read_b32 v112, a180
  v_accvgpr_read_b32 v113, a181
  v_accvgpr_read_b32 v114, a182
  v_accvgpr_read_b32 v115, a183
  v_pk_mul_f32 v[112:113], v[112:113], v[24:25]
  v_pk_mul_f32 v[114:115], v[114:115], v[26:27]
  v_cvt_pk_bf16_f32 v96, v94, v98
  v_cvt_pk_bf16_f32 v97, v102, v106
  ds_write_b64 v18, v[96:97] offset:768
  v_accvgpr_read_b32 v140, a184
  v_accvgpr_read_b32 v141, a185
  v_accvgpr_read_b32 v142, a186
  v_accvgpr_read_b32 v143, a187
  v_pk_mul_f32 v[140:141], v[140:141], v[24:25]
  v_pk_mul_f32 v[142:143], v[142:143], v[26:27]
  v_cvt_pk_bf16_f32 v94, v95, v99
  v_cvt_pk_bf16_f32 v95, v103, v107
  ds_write_b64 v20, v[94:95] offset:1152
  v_accvgpr_read_b32 v144, a188
  v_accvgpr_read_b32 v145, a189
  v_accvgpr_read_b32 v146, a190
  v_accvgpr_read_b32 v147, a191
  v_pk_mul_f32 v[144:145], v[144:145], v[24:25]
  v_pk_mul_f32 v[146:147], v[146:147], v[26:27]
  v_cvt_pk_bf16_f32 v10, v108, v112
  v_cvt_pk_bf16_f32 v11, v140, v144
  ds_write_b64 v20, v[10:11] offset:128
  v_accvgpr_read_b32 v92, a192
  v_accvgpr_read_b32 v93, a193
  v_accvgpr_read_b32 v94, a194
  v_accvgpr_read_b32 v95, a195
  v_pk_mul_f32 v[92:93], v[92:93], v[24:25]
  v_pk_mul_f32 v[94:95], v[94:95], v[26:27]
  v_cvt_pk_bf16_f32 v108, v109, v113
  v_cvt_pk_bf16_f32 v109, v141, v145
  ds_write_b64 v20, v[108:109] offset:512
  v_accvgpr_read_b32 v96, a196
  v_accvgpr_read_b32 v97, a197
  v_accvgpr_read_b32 v98, a198
  v_accvgpr_read_b32 v99, a199
  v_pk_mul_f32 v[96:97], v[96:97], v[24:25]
  v_pk_mul_f32 v[98:99], v[98:99], v[26:27]
  v_cvt_pk_bf16_f32 v112, v110, v114
  v_cvt_pk_bf16_f32 v113, v142, v146
  ds_write_b64 v18, v[112:113] offset:896
  v_accvgpr_read_b32 v100, a200
  v_accvgpr_read_b32 v101, a201
  v_accvgpr_read_b32 v102, a202
  v_accvgpr_read_b32 v103, a203
  v_pk_mul_f32 v[100:101], v[100:101], v[24:25]
  v_pk_mul_f32 v[102:103], v[102:103], v[26:27]
  v_cvt_pk_bf16_f32 v110, v111, v115
  v_cvt_pk_bf16_f32 v111, v143, v147
  ds_write_b64 v18, v[110:111] offset:1280
  v_accvgpr_read_b32 v104, a204
  v_accvgpr_read_b32 v105, a205
  v_accvgpr_read_b32 v106, a206
  v_accvgpr_read_b32 v107, a207
  v_pk_mul_f32 v[104:105], v[104:105], v[24:25]
  v_pk_mul_f32 v[106:107], v[106:107], v[26:27]
  v_cvt_pk_bf16_f32 v10, v92, v96
  v_cvt_pk_bf16_f32 v11, v100, v104
  ds_write_b64 v18, v[10:11] offset:256
  v_cvt_pk_bf16_f32 v92, v93, v97
  v_cvt_pk_bf16_f32 v93, v101, v105
  ds_write_b64 v20, v[92:93] offset:640
  v_cvt_pk_bf16_f32 v96, v94, v98
  v_cvt_pk_bf16_f32 v97, v102, v106
  ds_write_b64 v20, v[96:97] offset:1024
  v_cvt_pk_bf16_f32 v94, v95, v99
  v_cvt_pk_bf16_f32 v95, v103, v107
  ds_write_b64 v18, v[94:95] offset:1408
  ds_read_b64_tr_b16 a[160:161], v21 offset:0
  ds_read_b64_tr_b16 a[162:163], v19 offset:0
  ds_read_b64_tr_b16 a[164:165], v21 offset:1024
  ds_read_b64_tr_b16 a[166:167], v19 offset:1024
  ds_read_b64_tr_b16 a[168:169], v21 offset:2048
  ds_read_b64_tr_b16 a[170:171], v19 offset:2048
  ds_read_b64_tr_b16 a[172:173], v21 offset:3072
  ds_read_b64_tr_b16 a[174:175], v19 offset:3072
  ds_read_b64_tr_b16 a[176:177], v21 offset:4096
  ds_read_b64_tr_b16 a[178:179], v19 offset:4096
  ds_read_b64_tr_b16 a[180:181], v21 offset:5120
  ds_read_b64_tr_b16 a[182:183], v19 offset:5120
  v_accvgpr_read_b32 v92, a208
  v_accvgpr_read_b32 v93, a209
  v_accvgpr_read_b32 v94, a210
  v_accvgpr_read_b32 v95, a211
  v_pk_mul_f32 v[92:93], v[92:93], v[28:29]
  v_pk_mul_f32 v[94:95], v[94:95], v[30:31]
  v_accvgpr_read_b32 v96, a212
  v_accvgpr_read_b32 v97, a213
  v_accvgpr_read_b32 v98, a214
  v_accvgpr_read_b32 v99, a215
  v_pk_mul_f32 v[96:97], v[96:97], v[28:29]
  v_pk_mul_f32 v[98:99], v[98:99], v[30:31]
  v_accvgpr_read_b32 v100, a216
  v_accvgpr_read_b32 v101, a217
  v_accvgpr_read_b32 v102, a218
  v_accvgpr_read_b32 v103, a219
  v_pk_mul_f32 v[100:101], v[100:101], v[28:29]
  v_pk_mul_f32 v[102:103], v[102:103], v[30:31]
  v_accvgpr_read_b32 v104, a220
  v_accvgpr_read_b32 v105, a221
  v_accvgpr_read_b32 v106, a222
  v_accvgpr_read_b32 v107, a223
  v_pk_mul_f32 v[104:105], v[104:105], v[28:29]
  v_pk_mul_f32 v[106:107], v[106:107], v[30:31]
  v_cvt_pk_bf16_f32 v10, v92, v96
  v_cvt_pk_bf16_f32 v11, v100, v104
  ds_write_b64 v20, v[10:11] offset:6144
  v_accvgpr_read_b32 v108, a224
  v_accvgpr_read_b32 v109, a225
  v_accvgpr_read_b32 v110, a226
  v_accvgpr_read_b32 v111, a227
  v_pk_mul_f32 v[108:109], v[108:109], v[28:29]
  v_pk_mul_f32 v[110:111], v[110:111], v[30:31]
  v_cvt_pk_bf16_f32 v92, v93, v97
  v_cvt_pk_bf16_f32 v93, v101, v105
  ds_write_b64 v18, v[92:93] offset:6528
  v_accvgpr_read_b32 v112, a228
  v_accvgpr_read_b32 v113, a229
  v_accvgpr_read_b32 v114, a230
  v_accvgpr_read_b32 v115, a231
  v_pk_mul_f32 v[112:113], v[112:113], v[28:29]
  v_pk_mul_f32 v[114:115], v[114:115], v[30:31]
  v_cvt_pk_bf16_f32 v96, v94, v98
  v_cvt_pk_bf16_f32 v97, v102, v106
  ds_write_b64 v18, v[96:97] offset:6912
  v_accvgpr_read_b32 v140, a232
  v_accvgpr_read_b32 v141, a233
  v_accvgpr_read_b32 v142, a234
  v_accvgpr_read_b32 v143, a235
  v_pk_mul_f32 v[140:141], v[140:141], v[28:29]
  v_pk_mul_f32 v[142:143], v[142:143], v[30:31]
  v_cvt_pk_bf16_f32 v94, v95, v99
  v_cvt_pk_bf16_f32 v95, v103, v107
  ds_write_b64 v20, v[94:95] offset:7296
  s_mov_b32 s42, 24576
  s_waitcnt lgkmcnt(14)
  buffer_store_dwordx4 a[160:163], v22, s[28:31], s42 offen offset:0 nt
  v_accvgpr_read_b32 v144, a236
  v_accvgpr_read_b32 v145, a237
  v_accvgpr_read_b32 v146, a238
  v_accvgpr_read_b32 v147, a239
  v_pk_mul_f32 v[144:145], v[144:145], v[28:29]
  v_pk_mul_f32 v[146:147], v[146:147], v[30:31]
  v_cvt_pk_bf16_f32 v10, v108, v112
  v_cvt_pk_bf16_f32 v11, v140, v144
  ds_write_b64 v20, v[10:11] offset:6272
  s_waitcnt lgkmcnt(13)
  buffer_store_dwordx4 a[164:167], v22, s[28:31], s42 offen offset:1024 nt
  v_accvgpr_read_b32 v92, a240
  v_accvgpr_read_b32 v93, a241
  v_accvgpr_read_b32 v94, a242
  v_accvgpr_read_b32 v95, a243
  v_pk_mul_f32 v[92:93], v[92:93], v[28:29]
  v_pk_mul_f32 v[94:95], v[94:95], v[30:31]
  v_cvt_pk_bf16_f32 v108, v109, v113
  v_cvt_pk_bf16_f32 v109, v141, v145
  ds_write_b64 v20, v[108:109] offset:6656
  s_waitcnt lgkmcnt(12)
  buffer_store_dwordx4 a[168:171], v22, s[28:31], s42 offen offset:2048 nt
  v_accvgpr_read_b32 v96, a244
  v_accvgpr_read_b32 v97, a245
  v_accvgpr_read_b32 v98, a246
  v_accvgpr_read_b32 v99, a247
  v_pk_mul_f32 v[96:97], v[96:97], v[28:29]
  v_pk_mul_f32 v[98:99], v[98:99], v[30:31]
  v_cvt_pk_bf16_f32 v112, v110, v114
  v_cvt_pk_bf16_f32 v113, v142, v146
  ds_write_b64 v18, v[112:113] offset:7040
  s_waitcnt lgkmcnt(11)
  buffer_store_dwordx4 a[172:175], v22, s[28:31], s42 offen offset:3072 nt
  v_accvgpr_read_b32 v100, a248
  v_accvgpr_read_b32 v101, a249
  v_accvgpr_read_b32 v102, a250
  v_accvgpr_read_b32 v103, a251
  v_pk_mul_f32 v[100:101], v[100:101], v[28:29]
  v_pk_mul_f32 v[102:103], v[102:103], v[30:31]
  v_cvt_pk_bf16_f32 v110, v111, v115
  v_cvt_pk_bf16_f32 v111, v143, v147
  ds_write_b64 v18, v[110:111] offset:7424
  s_mov_b32 s42, 28672
  s_waitcnt lgkmcnt(10)
  buffer_store_dwordx4 a[176:179], v22, s[28:31], s42 offen offset:0 nt
  v_accvgpr_read_b32 v104, a252
  v_accvgpr_read_b32 v105, a253
  v_accvgpr_read_b32 v106, a254
  v_accvgpr_read_b32 v107, a255
  v_pk_mul_f32 v[104:105], v[104:105], v[28:29]
  v_pk_mul_f32 v[106:107], v[106:107], v[30:31]
  v_cvt_pk_bf16_f32 v10, v92, v96
  v_cvt_pk_bf16_f32 v11, v100, v104
  ds_write_b64 v18, v[10:11] offset:6400
  s_waitcnt lgkmcnt(9)
  buffer_store_dwordx4 a[180:183], v22, s[28:31], s42 offen offset:1024 nt
  v_cvt_pk_bf16_f32 v92, v93, v97
  v_cvt_pk_bf16_f32 v93, v101, v105
  ds_write_b64 v20, v[92:93] offset:6784
  v_cvt_pk_bf16_f32 v96, v94, v98
  v_cvt_pk_bf16_f32 v97, v102, v106
  ds_write_b64 v20, v[96:97] offset:7168
  v_cvt_pk_bf16_f32 v94, v95, v99
  v_cvt_pk_bf16_f32 v95, v103, v107
  ds_write_b64 v18, v[94:95] offset:7552
  ds_read_b64_tr_b16 a[208:209], v21 offset:6144
  ds_read_b64_tr_b16 a[210:211], v19 offset:6144
  ds_read_b64_tr_b16 a[212:213], v21 offset:7168
  ds_read_b64_tr_b16 a[214:215], v19 offset:7168
  ds_read_b64_tr_b16 a[216:217], v21 offset:8192
  ds_read_b64_tr_b16 a[218:219], v19 offset:8192
  ds_read_b64_tr_b16 a[220:221], v21 offset:9216
  ds_read_b64_tr_b16 a[222:223], v19 offset:9216
  ds_read_b64_tr_b16 a[224:225], v21 offset:10240
  ds_read_b64_tr_b16 a[226:227], v19 offset:10240
  ds_read_b64_tr_b16 a[228:229], v21 offset:11264
  ds_read_b64_tr_b16 a[230:231], v19 offset:11264
  s_mov_b32 s42, 30720
  s_waitcnt lgkmcnt(10)
  buffer_store_dwordx4 a[208:211], v22, s[28:31], s42 offen offset:0 nt
  s_waitcnt lgkmcnt(8)
  buffer_store_dwordx4 a[212:215], v22, s[28:31], s42 offen offset:1024 nt
  s_waitcnt lgkmcnt(6)
  buffer_store_dwordx4 a[216:219], v22, s[28:31], s42 offen offset:2048 nt
  s_waitcnt lgkmcnt(4)
  buffer_store_dwordx4 a[220:223], v22, s[28:31], s42 offen offset:3072 nt
  s_mov_b32 s42, 34816
  s_waitcnt lgkmcnt(2)
  buffer_store_dwordx4 a[224:227], v22, s[28:31], s42 offen offset:0 nt
  s_waitcnt lgkmcnt(0)
  buffer_store_dwordx4 a[228:231], v22, s[28:31], s42 offen offset:1024 nt
  v_cmp_lt_u32 s[44:45], s37, v2
  v_cmp_gt_u32 s[46:47], s38, v23
  s_nop 1
  s_or_b64 s[44:45], s[44:45], s[46:47]
  s_cmp_eq_u64 s[44:45], 0
  s_cbranch_scc1 L_inrange
  v_mov_b32 v10, 162912
  v_mov_b32 v11, 1
  ds_write_b32 v10, v11 offset:0
L_inrange:
  s_waitcnt lgkmcnt(0)
  s_barrier
  v_mov_b32 v11, 162912
  ds_read_b32 v11, v11 offset:0
  s_waitcnt lgkmcnt(0)
  v_readfirstlane_b32 s42, v11
  s_nop 1
  s_cmp_lg_u32 s42, 0
  s_cbranch_scc1 L_slow
L_end:
  s_endpgm
L_slow:
  s_waitcnt vmcnt(0) lgkmcnt(0)
  s_barrier
  v_mbcnt_lo_u32_b32 v4, -1, 0
  v_mbcnt_hi_u32_b32 v4, -1, v4
  v_mov_b32 v5, s32
  v_lshrrev_b32 v6, 4, v4
  v_lshlrev_b32 v6, 3, v6
  v_bfe_u32 v7, v4, 3, 1
  v_add_u32 v6, v6, v7
  v_lshl_add_u32 v6, v5, 1, v6
  v_mul_u32_u24 v6, 384, v6
  v_and_b32 v7, 7, v4
  v_lshl_add_u32 v2, v7, 4, v6
  v_and_b32 v6, 15, v4
  v_lshrrev_b32 v7, 4, v4
  v_bfe_u32 v8, v6, 1, 2
  v_mul_u32_u24 v8, 1056, v8
  v_lshrrev_b32 v9, 3, v6
  v_lshlrev_b32 v9, 1, v9
  v_and_b32 v0, 1, v6
  v_add_u32 v9, v9, v0
  v_lshl_add_u32 v0, v9, 7, v8
  v_lshl_add_u32 v0, v7, 4, v0
  v_lshrrev_b32 v6, 2, v4
  v_bfe_u32 v8, v6, 1, 2
  v_mul_u32_u24 v8, 1040, v8
  v_lshrrev_b32 v9, 3, v6
  v_lshlrev_b32 v9, 1, v9
  v_and_b32 v1, 1, v6
  v_add_u32 v9, v9, v1
  v_lshl_add_u32 v1, v9, 7, v8
  v_and_b32 v6, 1, v4
  v_lshl_add_u32 v1, v6, 3, v1
  v_bfe_u32 v6, v4, 1, 1
  v_lshl_add_u32 v1, v6, 6, v1
  v_add_u32 v1, 62880, v1
  v_mul_u32_u24 v3, 96, v5
  v_and_b32 v6, 15, v4
  v_add_u32 v3, v3, v6
  v_mul_u32_u24 v3, 384, v3
  v_lshl_add_u32 v3, v7, 4, v3
  s_mov_b32 s42, 0
  buffer_load_dwordx4 a[0:3], v3, s[24:27], s42 offen offset:0
  buffer_load_dwordx4 a[4:7], v3, s[24:27], s42 offen offset:64
  buffer_load_dwordx4 a[8:11], v3, s[24:27], s42 offen offset:128
  buffer_load_dwordx4 a[12:15], v3, s[24:27], s42 offen offset:192
  buffer_load_dwordx4 a[16:19], v3, s[24:27], s42 offen offset:256
  buffer_load_dwordx4 v[44:47], v3, s[24:27], s42 offen offset:320
  s_mov_b32 s42, 6144
  buffer_load_dwordx4 a[20:23], v3, s[24:27], s42 offen offset:0
  buffer_load_dwordx4 a[24:27], v3, s[24:27], s42 offen offset:64
  buffer_load_dwordx4 a[28:31], v3, s[24:27], s42 offen offset:128
  buffer_load_dwordx4 a[32:35], v3, s[24:27], s42 offen offset:192
  buffer_load_dwordx4 a[36:39], v3, s[24:27], s42 offen offset:256
  buffer_load_dwordx4 v[48:51], v3, s[24:27], s42 offen offset:320
  s_mov_b32 s42, 12288
  buffer_load_dwordx4 a[40:43], v3, s[24:27], s42 offen offset:0
  buffer_load_dwordx4 a[44:47], v3, s[24:27], s42 offen offset:64
  buffer_load_dwordx4 a[48:51], v3, s[24:27], s42 offen offset:128
  buffer_load_dwordx4 a[52:55], v3, s[24:27], s42 offen offset:192
  buffer_load_dwordx4 a[56:59], v3, s[24:27], s42 offen offset:256
  buffer_load_dwordx4 v[52:55], v3, s[24:27], s42 offen offset:320
  s_mov_b32 s42, 18432
  buffer_load_dwordx4 a[60:63], v3, s[24:27], s42 offen offset:0
  buffer_load_dwordx4 a[64:67], v3, s[24:27], s42 offen offset:64
  buffer_load_dwordx4 a[68:71], v3, s[24:27], s42 offen offset:128
  buffer_load_dwordx4 a[72:75], v3, s[24:27], s42 offen offset:192
  buffer_load_dwordx4 a[76:79], v3, s[24:27], s42 offen offset:256
  buffer_load_dwordx4 v[56:59], v3, s[24:27], s42 offen offset:320
  s_mov_b32 s42, 24576
  buffer_load_dwordx4 a[80:83], v3, s[24:27], s42 offen offset:0
  buffer_load_dwordx4 a[84:87], v3, s[24:27], s42 offen offset:64
  buffer_load_dwordx4 a[88:91], v3, s[24:27], s42 offen offset:128
  buffer_load_dwordx4 a[92:95], v3, s[24:27], s42 offen offset:192
  buffer_load_dwordx4 a[96:99], v3, s[24:27], s42 offen offset:256
  buffer_load_dwordx4 v[60:63], v3, s[24:27], s42 offen offset:320
  s_mov_b32 s42, 30720
  buffer_load_dwordx4 a[100:103], v3, s[24:27], s42 offen offset:0
  buffer_load_dwordx4 a[104:107], v3, s[24:27], s42 offen offset:64
  buffer_load_dwordx4 a[108:111], v3, s[24:27], s42 offen offset:128
  buffer_load_dwordx4 a[112:115], v3, s[24:27], s42 offen offset:192
  buffer_load_dwordx4 a[116:119], v3, s[24:27], s42 offen offset:256
  buffer_load_dwordx4 v[64:67], v3, s[24:27], s42 offen offset:320
  s_waitcnt vmcnt(0)
  v_mov_b32 v16, 0xff800000
  v_mov_b32 v17, 0xff800000
  v_mov_b32 v18, 0xff800000
  v_mov_b32 v19, 0xff800000
  v_mov_b32 v10, 0xff800000
  v_mov_b32 v11, 0xff800000
  s_mov_b32 s33, 0
L_slow_max:
  s_add_u32 m0, s41, 0
  s_nop 0
  buffer_load_dwordx4 v2, s[16:19], s33 offen offset:0 nt lds
  s_add_u32 m0, s41, 4064
  s_nop 0
  buffer_load_dwordx4 v2, s[16:19], s33 offen offset:128 nt lds
  s_add_u32 m0, s41, 8128
  s_nop 0
  buffer_load_dwordx4 v2, s[16:19], s33 offen offset:256 nt lds
  s_waitcnt vmcnt(0)
  s_barrier
  ds_read_b128 a[124:127], v0 offset:0
  ds_read_b128 a[128:131], v0 offset:64
  ds_read_b128 a[132:135], v0 offset:4192
  ds_read_b128 a[136:139], v0 offset:4256
  ds_read_b128 a[140:143], v0 offset:8384
  ds_read_b128 a[144:147], v0 offset:8448
  s_waitcnt lgkmcnt(5)
  v_mfma_f32_16x16x32_bf16 v[12:15], a[124:127], a[0:3], 0
  s_waitcnt lgkmcnt(4)
  v_mfma_f32_16x16x32_bf16 v[12:15], a[128:131], a[4:7], v[12:15]
  s_waitcnt lgkmcnt(3)
  v_mfma_f32_16x16x32_bf16 v[12:15], a[132:135], a[8:11], v[12:15]
  s_waitcnt lgkmcnt(2)
  v_mfma_f32_16x16x32_bf16 v[12:15], a[136:139], a[12:15], v[12:15]
  s_waitcnt lgkmcnt(1)
  v_mfma_f32_16x16x32_bf16 v[12:15], a[140:143], a[16:19], v[12:15]
  s_waitcnt lgkmcnt(0)
  v_mfma_f32_16x16x32_bf16 v[12:15], a[144:147], v[44:47], v[12:15]
  s_nop 7
  v_max3_f32 v16, v16, v12, v13
  v_max3_f32 v16, v16, v14, v15
  v_mfma_f32_16x16x32_bf16 v[12:15], a[124:127], a[20:23], 0
  v_mfma_f32_16x16x32_bf16 v[12:15], a[128:131], a[24:27], v[12:15]
  v_mfma_f32_16x16x32_bf16 v[12:15], a[132:135], a[28:31], v[12:15]
  v_mfma_f32_16x16x32_bf16 v[12:15], a[136:139], a[32:35], v[12:15]
  v_mfma_f32_16x16x32_bf16 v[12:15], a[140:143], a[36:39], v[12:15]
  v_mfma_f32_16x16x32_bf16 v[12:15], a[144:147], v[48:51], v[12:15]
  s_nop 7
  v_max3_f32 v17, v17, v12, v13
  v_max3_f32 v17, v17, v14, v15
  v_mfma_f32_16x16x32_bf16 v[12:15], a[124:127], a[40:43], 0
  v_mfma_f32_16x16x32_bf16 v[12:15], a[128:131], a[44:47], v[12:15]
  v_mfma_f32_16x16x32_bf16 v[12:15], a[132:135], a[48:51], v[12:15]
  v_mfma_f32_16x16x32_bf16 v[12:15], a[136:139], a[52:55], v[12:15]
  v_mfma_f32_16x16x32_bf16 v[12:15], a[140:143], a[56:59], v[12:15]
  v_mfma_f32_16x16x32_bf16 v[12:15], a[144:147], v[52:55], v[12:15]
  s_nop 7
  v_max3_f32 v18, v18, v12, v13
  v_max3_f32 v18, v18, v14, v15
  v_mfma_f32_16x16x32_bf16 v[12:15], a[124:127], a[60:63], 0
  v_mfma_f32_16x16x32_bf16 v[12:15], a[128:131], a[64:67], v[12:15]
  v_mfma_f32_16x16x32_bf16 v[12:15], a[132:135], a[68:71], v[12:15]
  v_mfma_f32_16x16x32_bf16 v[12:15], a[136:139], a[72:75], v[12:15]
  v_mfma_f32_16x16x32_bf16 v[12:15], a[140:143], a[76:79], v[12:15]
  v_mfma_f32_16x16x32_bf16 v[12:15], a[144:147], v[56:59], v[12:15]
  s_nop 7
  v_max3_f32 v19, v19, v12, v13
  v_max3_f32 v19, v19, v14, v15
  v_mfma_f32_16x16x32_bf16 v[12:15], a[124:127], a[80:83], 0
  v_mfma_f32_16x16x32_bf16 v[12:15], a[128:131], a[84:87], v[12:15]
  v_mfma_f32_16x16x32_bf16 v[12:15], a[132:135], a[88:91], v[12:15]
  v_mfma_f32_16x16x32_bf16 v[12:15], a[136:139], a[92:95], v[12:15]
  v_mfma_f32_16x16x32_bf16 v[12:15], a[140:143], a[96:99], v[12:15]
  v_mfma_f32_16x16x32_bf16 v[12:15], a[144:147], v[60:63], v[12:15]
  s_nop 7
  v_max3_f32 v10, v10, v12, v13
  v_max3_f32 v10, v10, v14, v15
  v_mfma_f32_16x16x32_bf16 v[12:15], a[124:127], a[100:103], 0
  v_mfma_f32_16x16x32_bf16 v[12:15], a[128:131], a[104:107], v[12:15]
  v_mfma_f32_16x16x32_bf16 v[12:15], a[132:135], a[108:111], v[12:15]
  v_mfma_f32_16x16x32_bf16 v[12:15], a[136:139], a[112:115], v[12:15]
  v_mfma_f32_16x16x32_bf16 v[12:15], a[140:143], a[116:119], v[12:15]
  v_mfma_f32_16x16x32_bf16 v[12:15], a[144:147], v[64:67], v[12:15]
  s_nop 7
  v_max3_f32 v11, v11, v12, v13
  v_max3_f32 v11, v11, v14, v15
  ds_read_b128 a[124:127], v0 offset:512
  ds_read_b128 a[128:131], v0 offset:576
  ds_read_b128 a[132:135], v0 offset:4704
  ds_read_b128 a[136:139], v0 offset:4768
  ds_read_b128 a[140:143], v0 offset:8896
  ds_read_b128 a[144:147], v0 offset:8960
  s_waitcnt lgkmcnt(5)
  v_mfma_f32_16x16x32_bf16 v[12:15], a[124:127], a[0:3], 0
  s_waitcnt lgkmcnt(4)
  v_mfma_f32_16x16x32_bf16 v[12:15], a[128:131], a[4:7], v[12:15]
  s_waitcnt lgkmcnt(3)
  v_mfma_f32_16x16x32_bf16 v[12:15], a[132:135], a[8:11], v[12:15]
  s_waitcnt lgkmcnt(2)
  v_mfma_f32_16x16x32_bf16 v[12:15], a[136:139], a[12:15], v[12:15]
  s_waitcnt lgkmcnt(1)
  v_mfma_f32_16x16x32_bf16 v[12:15], a[140:143], a[16:19], v[12:15]
  s_waitcnt lgkmcnt(0)
  v_mfma_f32_16x16x32_bf16 v[12:15], a[144:147], v[44:47], v[12:15]
  s_nop 7
  v_max3_f32 v16, v16, v12, v13
  v_max3_f32 v16, v16, v14, v15
  v_mfma_f32_16x16x32_bf16 v[12:15], a[124:127], a[20:23], 0
  v_mfma_f32_16x16x32_bf16 v[12:15], a[128:131], a[24:27], v[12:15]
  v_mfma_f32_16x16x32_bf16 v[12:15], a[132:135], a[28:31], v[12:15]
  v_mfma_f32_16x16x32_bf16 v[12:15], a[136:139], a[32:35], v[12:15]
  v_mfma_f32_16x16x32_bf16 v[12:15], a[140:143], a[36:39], v[12:15]
  v_mfma_f32_16x16x32_bf16 v[12:15], a[144:147], v[48:51], v[12:15]
  s_nop 7
  v_max3_f32 v17, v17, v12, v13
  v_max3_f32 v17, v17, v14, v15
  v_mfma_f32_16x16x32_bf16 v[12:15], a[124:127], a[40:43], 0
  v_mfma_f32_16x16x32_bf16 v[12:15], a[128:131], a[44:47], v[12:15]
  v_mfma_f32_16x16x32_bf16 v[12:15], a[132:135], a[48:51], v[12:15]
  v_mfma_f32_16x16x32_bf16 v[12:15], a[136:139], a[52:55], v[12:15]
  v_mfma_f32_16x16x32_bf16 v[12:15], a[140:143], a[56:59], v[12:15]
  v_mfma_f32_16x16x32_bf16 v[12:15], a[144:147], v[52:55], v[12:15]
  s_nop 7
  v_max3_f32 v18, v18, v12, v13
  v_max3_f32 v18, v18, v14, v15
  v_mfma_f32_16x16x32_bf16 v[12:15], a[124:127], a[60:63], 0
  v_mfma_f32_16x16x32_bf16 v[12:15], a[128:131], a[64:67], v[12:15]
  v_mfma_f32_16x16x32_bf16 v[12:15], a[132:135], a[68:71], v[12:15]
  v_mfma_f32_16x16x32_bf16 v[12:15], a[136:139], a[72:75], v[12:15]
  v_mfma_f32_16x16x32_bf16 v[12:15], a[140:143], a[76:79], v[12:15]
  v_mfma_f32_16x16x32_bf16 v[12:15], a[144:147], v[56:59], v[12:15]
  s_nop 7
  v_max3_f32 v19, v19, v12, v13
  v_max3_f32 v19, v19, v14, v15
  v_mfma_f32_16x16x32_bf16 v[12:15], a[124:127], a[80:83], 0
  v_mfma_f32_16x16x32_bf16 v[12:15], a[128:131], a[84:87], v[12:15]
  v_mfma_f32_16x16x32_bf16 v[12:15], a[132:135], a[88:91], v[12:15]
  v_mfma_f32_16x16x32_bf16 v[12:15], a[136:139], a[92:95], v[12:15]
  v_mfma_f32_16x16x32_bf16 v[12:15], a[140:143], a[96:99], v[12:15]
  v_mfma_f32_16x16x32_bf16 v[12:15], a[144:147], v[60:63], v[12:15]
  s_nop 7
  v_max3_f32 v10, v10, v12, v13
  v_max3_f32 v10, v10, v14, v15
  v_mfma_f32_16x16x32_bf16 v[12:15], a[124:127], a[100:103], 0
  v_mfma_f32_16x16x32_bf16 v[12:15], a[128:131], a[104:107], v[12:15]
  v_mfma_f32_16x16x32_bf16 v[12:15], a[132:135], a[108:111], v[12:15]
  v_mfma_f32_16x16x32_bf16 v[12:15], a[136:139], a[112:115], v[12:15]
  v_mfma_f32_16x16x32_bf16 v[12:15], a[140:143], a[116:119], v[12:15]
  v_mfma_f32_16x16x32_bf16 v[12:15], a[144:147], v[64:67], v[12:15]
  s_nop 7
  v_max3_f32 v11, v11, v12, v13
  v_max3_f32 v11, v11, v14, v15
  s_waitcnt lgkmcnt(0)
  s_barrier
  s_add_u32 s33, s33, 12288
  s_cmp_lt_u32 s33, 393216
  s_cbranch_scc1 L_slow_max
  v_mov_b32 v3, v16
  s_nop 1
  v_permlane32_swap_b32 v16, v3
  v_max_f32 v16, v16, v3
  v_mov_b32 v3, v16
  s_nop 1
  v_permlane16_swap_b32 v16, v3
  v_max_f32 v16, v16, v3
  v_mov_b32 v3, v17
  s_nop 1
  v_permlane32_swap_b32 v17, v3
  v_max_f32 v17, v17, v3
  v_mov_b32 v3, v17
  s_nop 1
  v_permlane16_swap_b32 v17, v3
  v_max_f32 v17, v17, v3
  v_mov_b32 v3, v18
  s_nop 1
  v_permlane32_swap_b32 v18, v3
  v_max_f32 v18, v18, v3
  v_mov_b32 v3, v18
  s_nop 1
  v_permlane16_swap_b32 v18, v3
  v_max_f32 v18, v18, v3
  v_mov_b32 v3, v19
  s_nop 1
  v_permlane32_swap_b32 v19, v3
  v_max_f32 v19, v19, v3
  v_mov_b32 v3, v19
  s_nop 1
  v_permlane16_swap_b32 v19, v3
  v_max_f32 v19, v19, v3
  v_mov_b32 v3, v10
  s_nop 1
  v_permlane32_swap_b32 v10, v3
  v_max_f32 v10, v10, v3
  v_mov_b32 v3, v10
  s_nop 1
  v_permlane16_swap_b32 v10, v3
  v_max_f32 v10, v10, v3
  v_mov_b32 v3, v11
  s_nop 1
  v_permlane32_swap_b32 v11, v3
  v_max_f32 v11, v11, v3
  v_mov_b32 v3, v11
  s_nop 1
  v_permlane16_swap_b32 v11, v3
  v_max_f32 v11, v11, v3
  v_mul_f32 v16, s40, v16
  v_mul_f32 v17, s40, v17
  v_mul_f32 v18, s40, v18
  v_mul_f32 v19, s40, v19
  v_mul_f32 v10, s40, v10
  v_mul_f32 v11, s40, v11
  v_accvgpr_write_b32 a156, 0
  v_accvgpr_write_b32 a157, 0
  v_accvgpr_write_b32 a158, 0
  v_accvgpr_write_b32 a159, 0
  v_accvgpr_write_b32 a160, 0
  v_accvgpr_write_b32 a161, 0
  v_accvgpr_write_b32 a162, 0
  v_accvgpr_write_b32 a163, 0
  v_accvgpr_write_b32 a164, 0
  v_accvgpr_write_b32 a165, 0
  v_accvgpr_write_b32 a166, 0
  v_accvgpr_write_b32 a167, 0
  v_accvgpr_write_b32 a168, 0
  v_accvgpr_write_b32 a169, 0
  v_accvgpr_write_b32 a170, 0
  v_accvgpr_write_b32 a171, 0
  v_accvgpr_write_b32 a172, 0
  v_accvgpr_write_b32 a173, 0
  v_accvgpr_write_b32 a174, 0
  v_accvgpr_write_b32 a175, 0
  v_accvgpr_write_b32 a176, 0
  v_accvgpr_write_b32 a177, 0
  v_accvgpr_write_b32 a178, 0
  v_accvgpr_write_b32 a179, 0
  v_accvgpr_write_b32 a180, 0
  v_accvgpr_write_b32 a181, 0
  v_accvgpr_write_b32 a182, 0
  v_accvgpr_write_b32 a183, 0
  v_accvgpr_write_b32 a184, 0
  v_accvgpr_write_b32 a185, 0
  v_accvgpr_write_b32 a186, 0
  v_accvgpr_write_b32 a187, 0
  v_accvgpr_write_b32 a188, 0
  v_accvgpr_write_b32 a189, 0
  v_accvgpr_write_b32 a190, 0
  v_accvgpr_write_b32 a191, 0
  v_accvgpr_write_b32 a192, 0
  v_accvgpr_write_b32 a193, 0
  v_accvgpr_write_b32 a194, 0
  v_accvgpr_write_b32 a195, 0
  v_accvgpr_write_b32 a196, 0
  v_accvgpr_write_b32 a197, 0
  v_accvgpr_write_b32 a198, 0
  v_accvgpr_write_b32 a199, 0
  v_accvgpr_write_b32 a200, 0
  v_accvgpr_write_b32 a201, 0
  v_accvgpr_write_b32 a202, 0
  v_accvgpr_write_b32 a203, 0
  v_accvgpr_write_b32 a204, 0
  v_accvgpr_write_b32 a205, 0
  v_accvgpr_write_b32 a206, 0
  v_accvgpr_write_b32 a207, 0
  v_accvgpr_write_b32 a208, 0
  v_accvgpr_write_b32 a209, 0
  v_accvgpr_write_b32 a210, 0
  v_accvgpr_write_b32 a211, 0
  v_accvgpr_write_b32 a212, 0
  v_accvgpr_write_b32 a213, 0
  v_accvgpr_write_b32 a214, 0
  v_accvgpr_write_b32 a215, 0
  v_accvgpr_write_b32 a216, 0
  v_accvgpr_write_b32 a217, 0
  v_accvgpr_write_b32 a218, 0
  v_accvgpr_write_b32 a219, 0
  v_accvgpr_write_b32 a220, 0
  v_accvgpr_write_b32 a221, 0
  v_accvgpr_write_b32 a222, 0
  v_accvgpr_write_b32 a223, 0
  v_accvgpr_write_b32 a224, 0
  v_accvgpr_write_b32 a225, 0
  v_accvgpr_write_b32 a226, 0
  v_accvgpr_write_b32 a227, 0
  v_accvgpr_write_b32 a228, 0
  v_accvgpr_write_b32 a229, 0
  v_accvgpr_write_b32 a230, 0
  v_accvgpr_write_b32 a231, 0
  v_accvgpr_write_b32 a232, 0
  v_accvgpr_write_b32 a233, 0
  v_accvgpr_write_b32 a234, 0
  v_accvgpr_write_b32 a235, 0
  v_accvgpr_write_b32 a236, 0
  v_accvgpr_write_b32 a237, 0
  v_accvgpr_write_b32 a238, 0
  v_accvgpr_write_b32 a239, 0
  v_accvgpr_write_b32 a240, 0
  v_accvgpr_write_b32 a241, 0
  v_accvgpr_write_b32 a242, 0
  v_accvgpr_write_b32 a243, 0
  v_accvgpr_write_b32 a244, 0
  v_accvgpr_write_b32 a245, 0
  v_accvgpr_write_b32 a246, 0
  v_accvgpr_write_b32 a247, 0
  v_accvgpr_write_b32 a248, 0
  v_accvgpr_write_b32 a249, 0
  v_accvgpr_write_b32 a250, 0
  v_accvgpr_write_b32 a251, 0
  v_accvgpr_write_b32 a252, 0
  v_accvgpr_write_b32 a253, 0
  v_accvgpr_write_b32 a254, 0
  v_accvgpr_write_b32 a255, 0
  v_mov_b32 v68, 0
  v_mov_b32 v69, 0
  v_mov_b32 v70, 0
  v_mov_b32 v71, 0
  v_mov_b32 v72, 0
  v_mov_b32 v73, 0
  v_mov_b32 v74, 0
  v_mov_b32 v75, 0
  v_mov_b32 v76, 0
  v_mov_b32 v77, 0
  v_mov_b32 v78, 0
  v_mov_b32 v79, 0
  v_mov_b32 v80, 0
  v_mov_b32 v81, 0
  v_mov_b32 v82, 0
  v_mov_b32 v83, 0
  v_mov_b32 v84, 0
  v_mov_b32 v85, 0
  v_mov_b32 v86, 0
  v_mov_b32 v87, 0
  v_mov_b32 v88, 0
  v_mov_b32 v89, 0
  v_mov_b32 v90, 0
  v_mov_b32 v91, 0
  v_mov_b32 v92, 0
  v_mov_b32 v93, 0
  v_mov_b32 v94, 0
  v_mov_b32 v95, 0
  v_mov_b32 v96, 0
  v_mov_b32 v97, 0
  v_mov_b32 v98, 0
  v_mov_b32 v99, 0
  v_mov_b32 v100, 0
  v_mov_b32 v101, 0
  v_mov_b32 v102, 0
  v_mov_b32 v103, 0
  v_mov_b32 v104, 0
  v_mov_b32 v105, 0
  v_mov_b32 v106, 0
  v_mov_b32 v107, 0
  v_mov_b32 v108, 0
  v_mov_b32 v109, 0
  v_mov_b32 v110, 0
  v_mov_b32 v111, 0
  v_mov_b32 v112, 0
  v_mov_b32 v113, 0
  v_mov_b32 v114, 0
  v_mov_b32 v115, 0
  v_mov_b32 v116, 0
  v_mov_b32 v117, 0
  v_mov_b32 v118, 0
  v_mov_b32 v119, 0
  v_mov_b32 v120, 0
  v_mov_b32 v121, 0
  v_mov_b32 v122, 0
  v_mov_b32 v123, 0
  v_mov_b32 v124, 0
  v_mov_b32 v125, 0
  v_mov_b32 v126, 0
  v_mov_b32 v127, 0
  v_mov_b32 v128, 0
  v_mov_b32 v129, 0
  v_mov_b32 v130, 0
  v_mov_b32 v131, 0
  v_mov_b32 v132, 0
  v_mov_b32 v133, 0
  v_mov_b32 v134, 0
  v_mov_b32 v135, 0
  v_mov_b32 v136, 0
  v_mov_b32 v137, 0
  v_mov_b32 v138, 0
  v_mov_b32 v139, 0
  v_mov_b32 v140, 0
  v_mov_b32 v141, 0
  v_mov_b32 v142, 0
  v_mov_b32 v143, 0
  v_mov_b32 v144, 0
  v_mov_b32 v145, 0
  v_mov_b32 v146, 0
  v_mov_b32 v147, 0
  v_mov_b32 v148, 0
  v_mov_b32 v149, 0
  v_mov_b32 v150, 0
  v_mov_b32 v151, 0
  v_mov_b32 v152, 0
  v_mov_b32 v153, 0
  v_mov_b32 v154, 0
  v_mov_b32 v155, 0
  v_mov_b32 v156, 0
  v_mov_b32 v157, 0
  v_mov_b32 v158, 0
  v_mov_b32 v159, 0
  v_mov_b32 v160, 0
  v_mov_b32 v161, 0
  v_mov_b32 v162, 0
  v_mov_b32 v163, 0
  v_mov_b32 v164, 0
  v_mov_b32 v165, 0
  v_mov_b32 v166, 0
  v_mov_b32 v167, 0
  v_mov_b32 v168, 0
  v_mov_b32 v169, 0
  v_mov_b32 v170, 0
  v_mov_b32 v171, 0
  v_mov_b32 v172, 0
  v_mov_b32 v173, 0
  v_mov_b32 v174, 0
  v_mov_b32 v175, 0
  v_mov_b32 v176, 0
  v_mov_b32 v177, 0
  v_mov_b32 v178, 0
  v_mov_b32 v179, 0
  v_mov_b32 v180, 0
  v_mov_b32 v181, 0
  v_mov_b32 v182, 0
  v_mov_b32 v183, 0
  v_mov_b32 v184, 0
  v_mov_b32 v185, 0
  v_mov_b32 v186, 0
  v_mov_b32 v187, 0
  v_mov_b32 v188, 0
  v_mov_b32 v189, 0
  v_mov_b32 v190, 0
  v_mov_b32 v191, 0
  v_mov_b32 v192, 0
  v_mov_b32 v193, 0
  v_mov_b32 v194, 0
  v_mov_b32 v195, 0
  v_mov_b32 v196, 0
  v_mov_b32 v197, 0
  v_mov_b32 v198, 0
  v_mov_b32 v199, 0
  v_mov_b32 v200, 0
  v_mov_b32 v201, 0
  v_mov_b32 v202, 0
  v_mov_b32 v203, 0
  v_mov_b32 v204, 0
  v_mov_b32 v205, 0
  v_mov_b32 v206, 0
  v_mov_b32 v207, 0
  v_mov_b32 v208, 0
  v_mov_b32 v209, 0
  v_mov_b32 v210, 0
  v_mov_b32 v211, 0
  v_mov_b32 v212, 0
  v_mov_b32 v213, 0
  v_mov_b32 v214, 0
  v_mov_b32 v215, 0
  v_mov_b32 v216, 0
  v_mov_b32 v217, 0
  v_mov_b32 v218, 0
  v_mov_b32 v219, 0
  v_mov_b32 v220, 0
  v_mov_b32 v221, 0
  v_mov_b32 v222, 0
  v_mov_b32 v223, 0
  v_mov_b32 v224, 0
  v_mov_b32 v225, 0
  v_mov_b32 v226, 0
  v_mov_b32 v227, 0
  v_mov_b32 v228, 0
  v_mov_b32 v229, 0
  v_mov_b32 v230, 0
  v_mov_b32 v231, 0
  v_mov_b32 v232, 0
  v_mov_b32 v233, 0
  v_mov_b32 v234, 0
  v_mov_b32 v235, 0
  v_mov_b32 v236, 0
  v_mov_b32 v237, 0
  v_mov_b32 v238, 0
  v_mov_b32 v239, 0
  v_mov_b32 v240, 0
  v_mov_b32 v241, 0
  v_mov_b32 v242, 0
  v_mov_b32 v243, 0
  v_mov_b32 v244, 0
  v_mov_b32 v245, 0
  v_mov_b32 v246, 0
  v_mov_b32 v247, 0
  v_mov_b32 v248, 0
  v_mov_b32 v249, 0
  v_mov_b32 v250, 0
  v_mov_b32 v251, 0
  v_mov_b32 v252, 0
  v_mov_b32 v253, 0
  v_mov_b32 v254, 0
  v_mov_b32 v255, 0
  v_mov_b32 v4, 0
  v_mov_b32 v5, 0
  v_mov_b32 v6, 0
  v_mov_b32 v7, 0
  v_mov_b32 v8, 0
  v_mov_b32 v9, 0
  s_mov_b32 s33, 0
L_slow_main:
  s_add_u32 m0, s41, 0
  s_nop 0
  buffer_load_dwordx4 v2, s[16:19], s33 offen offset:0 nt lds
  s_add_u32 m0, s41, 4064
  s_nop 0
  buffer_load_dwordx4 v2, s[16:19], s33 offen offset:128 nt lds
  s_add_u32 m0, s41, 8128
  s_nop 0
  buffer_load_dwordx4 v2, s[16:19], s33 offen offset:256 nt lds
  s_add_u32 m0, s97, 62880
  s_nop 0
  buffer_load_dwordx4 v2, s[20:23], s33 offen offset:0 nt lds
  s_add_u32 m0, s97, 66944
  s_nop 0
  buffer_load_dwordx4 v2, s[20:23], s33 offen offset:128 nt lds
  s_add_u32 m0, s97, 71008
  s_nop 0
  buffer_load_dwordx4 v2, s[20:23], s33 offen offset:256 nt lds
  s_waitcnt vmcnt(0)
  s_barrier
  ds_read_b128 a[124:127], v0 offset:0
  ds_read_b128 a[128:131], v0 offset:64
  ds_read_b128 a[132:135], v0 offset:4192
  ds_read_b128 a[136:139], v0 offset:4256
  ds_read_b128 a[140:143], v0 offset:8384
  ds_read_b128 a[144:147], v0 offset:8448
  s_waitcnt lgkmcnt(5)
  v_mfma_f32_16x16x32_bf16 v[12:15], a[124:127], a[0:3], 0
  s_waitcnt lgkmcnt(4)
  v_mfma_f32_16x16x32_bf16 v[12:15], a[128:131], a[4:7], v[12:15]
  s_waitcnt lgkmcnt(3)
  v_mfma_f32_16x16x32_bf16 v[12:15], a[132:135], a[8:11], v[12:15]
  s_waitcnt lgkmcnt(2)
  v_mfma_f32_16x16x32_bf16 v[12:15], a[136:139], a[12:15], v[12:15]
  s_waitcnt lgkmcnt(1)
  v_mfma_f32_16x16x32_bf16 v[12:15], a[140:143], a[16:19], v[12:15]
  s_waitcnt lgkmcnt(0)
  v_mfma_f32_16x16x32_bf16 v[12:15], a[144:147], v[44:47], v[12:15]
  s_nop 7
  v_fma_f32 v12, v12, s40, -v16
  v_fma_f32 v13, v13, s40, -v16
  v_fma_f32 v14, v14, s40, -v16
  v_fma_f32 v15, v15, s40, -v16
  v_exp_f32 v12, v12
  v_exp_f32 v13, v13
  v_exp_f32 v14, v14
  v_exp_f32 v15, v15
  v_add_f32 v4, v12, v4
  v_add_f32 v4, v13, v4
  v_add_f32 v4, v14, v4
  v_add_f32 v4, v15, v4
  v_cvt_pk_bf16_f32 v20, v12, v13
  v_cvt_pk_bf16_f32 v21, v14, v15
  v_mfma_f32_16x16x32_bf16 v[12:15], a[124:127], a[20:23], 0
  v_mfma_f32_16x16x32_bf16 v[12:15], a[128:131], a[24:27], v[12:15]
  v_mfma_f32_16x16x32_bf16 v[12:15], a[132:135], a[28:31], v[12:15]
  v_mfma_f32_16x16x32_bf16 v[12:15], a[136:139], a[32:35], v[12:15]
  v_mfma_f32_16x16x32_bf16 v[12:15], a[140:143], a[36:39], v[12:15]
  v_mfma_f32_16x16x32_bf16 v[12:15], a[144:147], v[48:51], v[12:15]
  s_nop 7
  v_fma_f32 v12, v12, s40, -v17
  v_fma_f32 v13, v13, s40, -v17
  v_fma_f32 v14, v14, s40, -v17
  v_fma_f32 v15, v15, s40, -v17
  v_exp_f32 v12, v12
  v_exp_f32 v13, v13
  v_exp_f32 v14, v14
  v_exp_f32 v15, v15
  v_add_f32 v5, v12, v5
  v_add_f32 v5, v13, v5
  v_add_f32 v5, v14, v5
  v_add_f32 v5, v15, v5
  v_cvt_pk_bf16_f32 v24, v12, v13
  v_cvt_pk_bf16_f32 v25, v14, v15
  v_mfma_f32_16x16x32_bf16 v[12:15], a[124:127], a[40:43], 0
  v_mfma_f32_16x16x32_bf16 v[12:15], a[128:131], a[44:47], v[12:15]
  v_mfma_f32_16x16x32_bf16 v[12:15], a[132:135], a[48:51], v[12:15]
  v_mfma_f32_16x16x32_bf16 v[12:15], a[136:139], a[52:55], v[12:15]
  v_mfma_f32_16x16x32_bf16 v[12:15], a[140:143], a[56:59], v[12:15]
  v_mfma_f32_16x16x32_bf16 v[12:15], a[144:147], v[52:55], v[12:15]
  s_nop 7
  v_fma_f32 v12, v12, s40, -v18
  v_fma_f32 v13, v13, s40, -v18
  v_fma_f32 v14, v14, s40, -v18
  v_fma_f32 v15, v15, s40, -v18
  v_exp_f32 v12, v12
  v_exp_f32 v13, v13
  v_exp_f32 v14, v14
  v_exp_f32 v15, v15
  v_add_f32 v6, v12, v6
  v_add_f32 v6, v13, v6
  v_add_f32 v6, v14, v6
  v_add_f32 v6, v15, v6
  v_cvt_pk_bf16_f32 v28, v12, v13
  v_cvt_pk_bf16_f32 v29, v14, v15
  v_mfma_f32_16x16x32_bf16 v[12:15], a[124:127], a[60:63], 0
  v_mfma_f32_16x16x32_bf16 v[12:15], a[128:131], a[64:67], v[12:15]
  v_mfma_f32_16x16x32_bf16 v[12:15], a[132:135], a[68:71], v[12:15]
  v_mfma_f32_16x16x32_bf16 v[12:15], a[136:139], a[72:75], v[12:15]
  v_mfma_f32_16x16x32_bf16 v[12:15], a[140:143], a[76:79], v[12:15]
  v_mfma_f32_16x16x32_bf16 v[12:15], a[144:147], v[56:59], v[12:15]
  s_nop 7
  v_fma_f32 v12, v12, s40, -v19
  v_fma_f32 v13, v13, s40, -v19
  v_fma_f32 v14, v14, s40, -v19
  v_fma_f32 v15, v15, s40, -v19
  v_exp_f32 v12, v12
  v_exp_f32 v13, v13
  v_exp_f32 v14, v14
  v_exp_f32 v15, v15
  v_add_f32 v7, v12, v7
  v_add_f32 v7, v13, v7
  v_add_f32 v7, v14, v7
  v_add_f32 v7, v15, v7
  v_cvt_pk_bf16_f32 v32, v12, v13
  v_cvt_pk_bf16_f32 v33, v14, v15
  v_mfma_f32_16x16x32_bf16 v[12:15], a[124:127], a[80:83], 0
  v_mfma_f32_16x16x32_bf16 v[12:15], a[128:131], a[84:87], v[12:15]
  v_mfma_f32_16x16x32_bf16 v[12:15], a[132:135], a[88:91], v[12:15]
  v_mfma_f32_16x16x32_bf16 v[12:15], a[136:139], a[92:95], v[12:15]
  v_mfma_f32_16x16x32_bf16 v[12:15], a[140:143], a[96:99], v[12:15]
  v_mfma_f32_16x16x32_bf16 v[12:15], a[144:147], v[60:63], v[12:15]
  s_nop 7
  v_fma_f32 v12, v12, s40, -v10
  v_fma_f32 v13, v13, s40, -v10
  v_fma_f32 v14, v14, s40, -v10
  v_fma_f32 v15, v15, s40, -v10
  v_exp_f32 v12, v12
  v_exp_f32 v13, v13
  v_exp_f32 v14, v14
  v_exp_f32 v15, v15
  v_add_f32 v8, v12, v8
  v_add_f32 v8, v13, v8
  v_add_f32 v8, v14, v8
  v_add_f32 v8, v15, v8
  v_cvt_pk_bf16_f32 v36, v12, v13
  v_cvt_pk_bf16_f32 v37, v14, v15
  v_mfma_f32_16x16x32_bf16 v[12:15], a[124:127], a[100:103], 0
  v_mfma_f32_16x16x32_bf16 v[12:15], a[128:131], a[104:107], v[12:15]
  v_mfma_f32_16x16x32_bf16 v[12:15], a[132:135], a[108:111], v[12:15]
  v_mfma_f32_16x16x32_bf16 v[12:15], a[136:139], a[112:115], v[12:15]
  v_mfma_f32_16x16x32_bf16 v[12:15], a[140:143], a[116:119], v[12:15]
  v_mfma_f32_16x16x32_bf16 v[12:15], a[144:147], v[64:67], v[12:15]
  s_nop 7
  v_fma_f32 v12, v12, s40, -v11
  v_fma_f32 v13, v13, s40, -v11
  v_fma_f32 v14, v14, s40, -v11
  v_fma_f32 v15, v15, s40, -v11
  v_exp_f32 v12, v12
  v_exp_f32 v13, v13
  v_exp_f32 v14, v14
  v_exp_f32 v15, v15
  v_add_f32 v9, v12, v9
  v_add_f32 v9, v13, v9
  v_add_f32 v9, v14, v9
  v_add_f32 v9, v15, v9
  v_cvt_pk_bf16_f32 v40, v12, v13
  v_cvt_pk_bf16_f32 v41, v14, v15
  ds_read_b128 a[124:127], v0 offset:512
  ds_read_b128 a[128:131], v0 offset:576
  ds_read_b128 a[132:135], v0 offset:4704
  ds_read_b128 a[136:139], v0 offset:4768
  ds_read_b128 a[140:143], v0 offset:8896
  ds_read_b128 a[144:147], v0 offset:8960
  s_waitcnt lgkmcnt(5)
  v_mfma_f32_16x16x32_bf16 v[12:15], a[124:127], a[0:3], 0
  s_waitcnt lgkmcnt(4)
  v_mfma_f32_16x16x32_bf16 v[12:15], a[128:131], a[4:7], v[12:15]
  s_waitcnt lgkmcnt(3)
  v_mfma_f32_16x16x32_bf16 v[12:15], a[132:135], a[8:11], v[12:15]
  s_waitcnt lgkmcnt(2)
  v_mfma_f32_16x16x32_bf16 v[12:15], a[136:139], a[12:15], v[12:15]
  s_waitcnt lgkmcnt(1)
  v_mfma_f32_16x16x32_bf16 v[12:15], a[140:143], a[16:19], v[12:15]
  s_waitcnt lgkmcnt(0)
  v_mfma_f32_16x16x32_bf16 v[12:15], a[144:147], v[44:47], v[12:15]
  s_nop 7
  v_fma_f32 v12, v12, s40, -v16
  v_fma_f32 v13, v13, s40, -v16
  v_fma_f32 v14, v14, s40, -v16
  v_fma_f32 v15, v15, s40, -v16
  v_exp_f32 v12, v12
  v_exp_f32 v13, v13
  v_exp_f32 v14, v14
  v_exp_f32 v15, v15
  v_add_f32 v4, v12, v4
  v_add_f32 v4, v13, v4
  v_add_f32 v4, v14, v4
  v_add_f32 v4, v15, v4
  v_cvt_pk_bf16_f32 v22, v12, v13
  v_cvt_pk_bf16_f32 v23, v14, v15
  v_mfma_f32_16x16x32_bf16 v[12:15], a[124:127], a[20:23], 0
  v_mfma_f32_16x16x32_bf16 v[12:15], a[128:131], a[24:27], v[12:15]
  v_mfma_f32_16x16x32_bf16 v[12:15], a[132:135], a[28:31], v[12:15]
  v_mfma_f32_16x16x32_bf16 v[12:15], a[136:139], a[32:35], v[12:15]
  v_mfma_f32_16x16x32_bf16 v[12:15], a[140:143], a[36:39], v[12:15]
  v_mfma_f32_16x16x32_bf16 v[12:15], a[144:147], v[48:51], v[12:15]
  s_nop 7
  v_fma_f32 v12, v12, s40, -v17
  v_fma_f32 v13, v13, s40, -v17
  v_fma_f32 v14, v14, s40, -v17
  v_fma_f32 v15, v15, s40, -v17
  v_exp_f32 v12, v12
  v_exp_f32 v13, v13
  v_exp_f32 v14, v14
  v_exp_f32 v15, v15
  v_add_f32 v5, v12, v5
  v_add_f32 v5, v13, v5
  v_add_f32 v5, v14, v5
  v_add_f32 v5, v15, v5
  v_cvt_pk_bf16_f32 v26, v12, v13
  v_cvt_pk_bf16_f32 v27, v14, v15
  v_mfma_f32_16x16x32_bf16 v[12:15], a[124:127], a[40:43], 0
  v_mfma_f32_16x16x32_bf16 v[12:15], a[128:131], a[44:47], v[12:15]
  v_mfma_f32_16x16x32_bf16 v[12:15], a[132:135], a[48:51], v[12:15]
  v_mfma_f32_16x16x32_bf16 v[12:15], a[136:139], a[52:55], v[12:15]
  v_mfma_f32_16x16x32_bf16 v[12:15], a[140:143], a[56:59], v[12:15]
  v_mfma_f32_16x16x32_bf16 v[12:15], a[144:147], v[52:55], v[12:15]
  s_nop 7
  v_fma_f32 v12, v12, s40, -v18
  v_fma_f32 v13, v13, s40, -v18
  v_fma_f32 v14, v14, s40, -v18
  v_fma_f32 v15, v15, s40, -v18
  v_exp_f32 v12, v12
  v_exp_f32 v13, v13
  v_exp_f32 v14, v14
  v_exp_f32 v15, v15
  v_add_f32 v6, v12, v6
  v_add_f32 v6, v13, v6
  v_add_f32 v6, v14, v6
  v_add_f32 v6, v15, v6
  v_cvt_pk_bf16_f32 v30, v12, v13
  v_cvt_pk_bf16_f32 v31, v14, v15
  v_mfma_f32_16x16x32_bf16 v[12:15], a[124:127], a[60:63], 0
  v_mfma_f32_16x16x32_bf16 v[12:15], a[128:131], a[64:67], v[12:15]
  v_mfma_f32_16x16x32_bf16 v[12:15], a[132:135], a[68:71], v[12:15]
  v_mfma_f32_16x16x32_bf16 v[12:15], a[136:139], a[72:75], v[12:15]
  v_mfma_f32_16x16x32_bf16 v[12:15], a[140:143], a[76:79], v[12:15]
  v_mfma_f32_16x16x32_bf16 v[12:15], a[144:147], v[56:59], v[12:15]
  s_nop 7
  v_fma_f32 v12, v12, s40, -v19
  v_fma_f32 v13, v13, s40, -v19
  v_fma_f32 v14, v14, s40, -v19
  v_fma_f32 v15, v15, s40, -v19
  v_exp_f32 v12, v12
  v_exp_f32 v13, v13
  v_exp_f32 v14, v14
  v_exp_f32 v15, v15
  v_add_f32 v7, v12, v7
  v_add_f32 v7, v13, v7
  v_add_f32 v7, v14, v7
  v_add_f32 v7, v15, v7
  v_cvt_pk_bf16_f32 v34, v12, v13
  v_cvt_pk_bf16_f32 v35, v14, v15
  v_mfma_f32_16x16x32_bf16 v[12:15], a[124:127], a[80:83], 0
  v_mfma_f32_16x16x32_bf16 v[12:15], a[128:131], a[84:87], v[12:15]
  v_mfma_f32_16x16x32_bf16 v[12:15], a[132:135], a[88:91], v[12:15]
  v_mfma_f32_16x16x32_bf16 v[12:15], a[136:139], a[92:95], v[12:15]
  v_mfma_f32_16x16x32_bf16 v[12:15], a[140:143], a[96:99], v[12:15]
  v_mfma_f32_16x16x32_bf16 v[12:15], a[144:147], v[60:63], v[12:15]
  s_nop 7
  v_fma_f32 v12, v12, s40, -v10
  v_fma_f32 v13, v13, s40, -v10
  v_fma_f32 v14, v14, s40, -v10
  v_fma_f32 v15, v15, s40, -v10
  v_exp_f32 v12, v12
  v_exp_f32 v13, v13
  v_exp_f32 v14, v14
  v_exp_f32 v15, v15
  v_add_f32 v8, v12, v8
  v_add_f32 v8, v13, v8
  v_add_f32 v8, v14, v8
  v_add_f32 v8, v15, v8
  v_cvt_pk_bf16_f32 v38, v12, v13
  v_cvt_pk_bf16_f32 v39, v14, v15
  v_mfma_f32_16x16x32_bf16 v[12:15], a[124:127], a[100:103], 0
  v_mfma_f32_16x16x32_bf16 v[12:15], a[128:131], a[104:107], v[12:15]
  v_mfma_f32_16x16x32_bf16 v[12:15], a[132:135], a[108:111], v[12:15]
  v_mfma_f32_16x16x32_bf16 v[12:15], a[136:139], a[112:115], v[12:15]
  v_mfma_f32_16x16x32_bf16 v[12:15], a[140:143], a[116:119], v[12:15]
  v_mfma_f32_16x16x32_bf16 v[12:15], a[144:147], v[64:67], v[12:15]
  s_nop 7
  v_fma_f32 v12, v12, s40, -v11
  v_fma_f32 v13, v13, s40, -v11
  v_fma_f32 v14, v14, s40, -v11
  v_fma_f32 v15, v15, s40, -v11
  v_exp_f32 v12, v12
  v_exp_f32 v13, v13
  v_exp_f32 v14, v14
  v_exp_f32 v15, v15
  v_add_f32 v9, v12, v9
  v_add_f32 v9, v13, v9
  v_add_f32 v9, v14, v9
  v_add_f32 v9, v15, v9
  v_cvt_pk_bf16_f32 v42, v12, v13
  v_cvt_pk_bf16_f32 v43, v14, v15
  ds_read_b64_tr_b16 a[148:149], v1 offset:0
  ds_read_b64_tr_b16 a[150:151], v1 offset:512
  s_waitcnt lgkmcnt(0)
  v_mfma_f32_16x16x32_bf16 v[68:71], v[20:23], a[148:151], v[68:71]
  v_mfma_f32_16x16x32_bf16 v[116:119], v[24:27], a[148:151], v[116:119]
  v_mfma_f32_16x16x32_bf16 v[164:167], v[28:31], a[148:151], v[164:167]
  v_mfma_f32_16x16x32_bf16 v[212:215], v[32:35], a[148:151], v[212:215]
  v_mfma_f32_16x16x32_bf16 a[160:163], v[36:39], a[148:151], a[160:163]
  v_mfma_f32_16x16x32_bf16 a[208:211], v[40:43], a[148:151], a[208:211]
  ds_read_b64_tr_b16 a[152:153], v1 offset:16
  ds_read_b64_tr_b16 a[154:155], v1 offset:528
  s_waitcnt lgkmcnt(0)
  v_mfma_f32_16x16x32_bf16 v[72:75], v[20:23], a[152:155], v[72:75]
  v_mfma_f32_16x16x32_bf16 v[120:123], v[24:27], a[152:155], v[120:123]
  v_mfma_f32_16x16x32_bf16 v[168:171], v[28:31], a[152:155], v[168:171]
  v_mfma_f32_16x16x32_bf16 v[216:219], v[32:35], a[152:155], v[216:219]
  v_mfma_f32_16x16x32_bf16 a[164:167], v[36:39], a[152:155], a[164:167]
  v_mfma_f32_16x16x32_bf16 a[212:215], v[40:43], a[152:155], a[212:215]
  ds_read_b64_tr_b16 a[148:149], v1 offset:32
  ds_read_b64_tr_b16 a[150:151], v1 offset:544
  s_waitcnt lgkmcnt(0)
  v_mfma_f32_16x16x32_bf16 v[76:79], v[20:23], a[148:151], v[76:79]
  v_mfma_f32_16x16x32_bf16 v[124:127], v[24:27], a[148:151], v[124:127]
  v_mfma_f32_16x16x32_bf16 v[172:175], v[28:31], a[148:151], v[172:175]
  v_mfma_f32_16x16x32_bf16 v[220:223], v[32:35], a[148:151], v[220:223]
  v_mfma_f32_16x16x32_bf16 a[168:171], v[36:39], a[148:151], a[168:171]
  v_mfma_f32_16x16x32_bf16 a[216:219], v[40:43], a[148:151], a[216:219]
  ds_read_b64_tr_b16 a[152:153], v1 offset:48
  ds_read_b64_tr_b16 a[154:155], v1 offset:560
  s_waitcnt lgkmcnt(0)
  v_mfma_f32_16x16x32_bf16 v[80:83], v[20:23], a[152:155], v[80:83]
  v_mfma_f32_16x16x32_bf16 v[128:131], v[24:27], a[152:155], v[128:131]
  v_mfma_f32_16x16x32_bf16 v[176:179], v[28:31], a[152:155], v[176:179]
  v_mfma_f32_16x16x32_bf16 v[224:227], v[32:35], a[152:155], v[224:227]
  v_mfma_f32_16x16x32_bf16 a[172:175], v[36:39], a[152:155], a[172:175]
  v_mfma_f32_16x16x32_bf16 a[220:223], v[40:43], a[152:155], a[220:223]
  ds_read_b64_tr_b16 a[148:149], v1 offset:4192
  ds_read_b64_tr_b16 a[150:151], v1 offset:4704
  s_waitcnt lgkmcnt(0)
  v_mfma_f32_16x16x32_bf16 v[84:87], v[20:23], a[148:151], v[84:87]
  v_mfma_f32_16x16x32_bf16 v[132:135], v[24:27], a[148:151], v[132:135]
  v_mfma_f32_16x16x32_bf16 v[180:183], v[28:31], a[148:151], v[180:183]
  v_mfma_f32_16x16x32_bf16 v[228:231], v[32:35], a[148:151], v[228:231]
  v_mfma_f32_16x16x32_bf16 a[176:179], v[36:39], a[148:151], a[176:179]
  v_mfma_f32_16x16x32_bf16 a[224:227], v[40:43], a[148:151], a[224:227]
  ds_read_b64_tr_b16 a[152:153], v1 offset:4208
  ds_read_b64_tr_b16 a[154:155], v1 offset:4720
  s_waitcnt lgkmcnt(0)
  v_mfma_f32_16x16x32_bf16 v[88:91], v[20:23], a[152:155], v[88:91]
  v_mfma_f32_16x16x32_bf16 v[136:139], v[24:27], a[152:155], v[136:139]
  v_mfma_f32_16x16x32_bf16 v[184:187], v[28:31], a[152:155], v[184:187]
  v_mfma_f32_16x16x32_bf16 v[232:235], v[32:35], a[152:155], v[232:235]
  v_mfma_f32_16x16x32_bf16 a[180:183], v[36:39], a[152:155], a[180:183]
  v_mfma_f32_16x16x32_bf16 a[228:231], v[40:43], a[152:155], a[228:231]
  ds_read_b64_tr_b16 a[148:149], v1 offset:4224
  ds_read_b64_tr_b16 a[150:151], v1 offset:4736
  s_waitcnt lgkmcnt(0)
  v_mfma_f32_16x16x32_bf16 v[92:95], v[20:23], a[148:151], v[92:95]
  v_mfma_f32_16x16x32_bf16 v[140:143], v[24:27], a[148:151], v[140:143]
  v_mfma_f32_16x16x32_bf16 v[188:191], v[28:31], a[148:151], v[188:191]
  v_mfma_f32_16x16x32_bf16 v[236:239], v[32:35], a[148:151], v[236:239]
  v_mfma_f32_16x16x32_bf16 a[184:187], v[36:39], a[148:151], a[184:187]
  v_mfma_f32_16x16x32_bf16 a[232:235], v[40:43], a[148:151], a[232:235]
  ds_read_b64_tr_b16 a[152:153], v1 offset:4240
  ds_read_b64_tr_b16 a[154:155], v1 offset:4752
  s_waitcnt lgkmcnt(0)
  v_mfma_f32_16x16x32_bf16 v[96:99], v[20:23], a[152:155], v[96:99]
  v_mfma_f32_16x16x32_bf16 v[144:147], v[24:27], a[152:155], v[144:147]
  v_mfma_f32_16x16x32_bf16 v[192:195], v[28:31], a[152:155], v[192:195]
  v_mfma_f32_16x16x32_bf16 v[240:243], v[32:35], a[152:155], v[240:243]
  v_mfma_f32_16x16x32_bf16 a[188:191], v[36:39], a[152:155], a[188:191]
  v_mfma_f32_16x16x32_bf16 a[236:239], v[40:43], a[152:155], a[236:239]
  ds_read_b64_tr_b16 a[148:149], v1 offset:8384
  ds_read_b64_tr_b16 a[150:151], v1 offset:8896
  s_waitcnt lgkmcnt(0)
  v_mfma_f32_16x16x32_bf16 v[100:103], v[20:23], a[148:151], v[100:103]
  v_mfma_f32_16x16x32_bf16 v[148:151], v[24:27], a[148:151], v[148:151]
  v_mfma_f32_16x16x32_bf16 v[196:199], v[28:31], a[148:151], v[196:199]
  v_mfma_f32_16x16x32_bf16 v[244:247], v[32:35], a[148:151], v[244:247]
  v_mfma_f32_16x16x32_bf16 a[192:195], v[36:39], a[148:151], a[192:195]
  v_mfma_f32_16x16x32_bf16 a[240:243], v[40:43], a[148:151], a[240:243]
  ds_read_b64_tr_b16 a[152:153], v1 offset:8400
  ds_read_b64_tr_b16 a[154:155], v1 offset:8912
  s_waitcnt lgkmcnt(0)
  v_mfma_f32_16x16x32_bf16 v[104:107], v[20:23], a[152:155], v[104:107]
  v_mfma_f32_16x16x32_bf16 v[152:155], v[24:27], a[152:155], v[152:155]
  v_mfma_f32_16x16x32_bf16 v[200:203], v[28:31], a[152:155], v[200:203]
  v_mfma_f32_16x16x32_bf16 v[248:251], v[32:35], a[152:155], v[248:251]
  v_mfma_f32_16x16x32_bf16 a[196:199], v[36:39], a[152:155], a[196:199]
  v_mfma_f32_16x16x32_bf16 a[244:247], v[40:43], a[152:155], a[244:247]
  ds_read_b64_tr_b16 a[148:149], v1 offset:8416
  ds_read_b64_tr_b16 a[150:151], v1 offset:8928
  s_waitcnt lgkmcnt(0)
  v_mfma_f32_16x16x32_bf16 v[108:111], v[20:23], a[148:151], v[108:111]
  v_mfma_f32_16x16x32_bf16 v[156:159], v[24:27], a[148:151], v[156:159]
  v_mfma_f32_16x16x32_bf16 v[204:207], v[28:31], a[148:151], v[204:207]
  v_mfma_f32_16x16x32_bf16 v[252:255], v[32:35], a[148:151], v[252:255]
  v_mfma_f32_16x16x32_bf16 a[200:203], v[36:39], a[148:151], a[200:203]
  v_mfma_f32_16x16x32_bf16 a[248:251], v[40:43], a[148:151], a[248:251]
  ds_read_b64_tr_b16 a[152:153], v1 offset:8432
  ds_read_b64_tr_b16 a[154:155], v1 offset:8944
  s_waitcnt lgkmcnt(0)
  v_mfma_f32_16x16x32_bf16 v[112:115], v[20:23], a[152:155], v[112:115]
  v_mfma_f32_16x16x32_bf16 v[160:163], v[24:27], a[152:155], v[160:163]
  v_mfma_f32_16x16x32_bf16 v[208:211], v[28:31], a[152:155], v[208:211]
  v_mfma_f32_16x16x32_bf16 a[156:159], v[32:35], a[152:155], a[156:159]
  v_mfma_f32_16x16x32_bf16 a[204:207], v[36:39], a[152:155], a[204:207]
  v_mfma_f32_16x16x32_bf16 a[252:255], v[40:43], a[152:155], a[252:255]
  s_waitcnt lgkmcnt(0)
  s_barrier
  s_add_u32 s33, s33, 12288
  s_cmp_lt_u32 s33, 393216
  s_cbranch_scc1 L_slow_main
  v_mbcnt_lo_u32_b32 v10, -1, 0
  v_mbcnt_hi_u32_b32 v10, -1, v10
  s_lshr_b32 s42, s32, 1
  s_mul_i32 s42, s42, 75456
  s_and_b32 s36, s32, 1
  s_mul_i32 s36, s36, 12288
  s_add_u32 s42, s42, s36
  s_add_u32 s42, s42, 25216
  s_and_b32 s42, s42, 0xffffff80
  v_and_b32 v11, 48, v10
  v_mul_u32_u24 v20, 96, v11
  v_lshl_add_u32 v21, v11, 4, s42
  v_and_b32 v11, 7, v10
  v_lshl_add_u32 v20, v11, 4, v20
  v_and_b32 v11, 8, v10
  v_add3_u32 v20, v20, v11, s42
  v_and_b32 v11, 28, v10
  v_lshl_add_u32 v21, v11, 2, v21
  v_and_b32 v11, 2, v10
  v_lshl_add_u32 v21, v11, 6, v21
  v_and_b32 v11, 1, v10
  v_lshl_add_u32 v21, v11, 3, v21
  s_mul_i32 s42, s32, 36864
  v_lshl_add_u32 v22, v10, 4, s42
  v_mov_b32 v16, 1.0
  s_nop 1
  v_mfma_f32_16x16x4_f32 v[24:27], v4, v16, 0
  v_mfma_f32_16x16x4_f32 v[28:31], v5, v16, 0
  v_mfma_f32_16x16x4_f32 v[32:35], v6, v16, 0
  v_mfma_f32_16x16x4_f32 v[12:15], v7, v16, 0
  s_nop 8
  v_rcp_f32 v24, v24
  v_rcp_f32 v25, v25
  v_rcp_f32 v26, v26
  v_rcp_f32 v27, v27
  v_rcp_f32 v28, v28
  v_rcp_f32 v29, v29
  v_rcp_f32 v30, v30
  v_rcp_f32 v31, v31
  v_rcp_f32 v32, v32
  v_rcp_f32 v33, v33
  v_rcp_f32 v34, v34
  v_rcp_f32 v35, v35
  v_rcp_f32 v12, v12
  v_rcp_f32 v13, v13
  v_rcp_f32 v14, v14
  v_rcp_f32 v15, v15
  v_xor_b32 v18, 64, v20
  v_xor_b32 v19, 64, v21
  v_pk_mul_f32 v[68:69], v[68:69], v[24:25]
  v_pk_mul_f32 v[70:71], v[70:71], v[26:27]
  v_pk_mul_f32 v[72:73], v[72:73], v[24:25]
  v_pk_mul_f32 v[74:75], v[74:75], v[26:27]
  v_pk_mul_f32 v[76:77], v[76:77], v[24:25]
  v_pk_mul_f32 v[78:79], v[78:79], v[26:27]
  v_pk_mul_f32 v[80:81], v[80:81], v[24:25]
  v_pk_mul_f32 v[82:83], v[82:83], v[26:27]
  v_cvt_pk_bf16_f32 v10, v68, v72
  v_cvt_pk_bf16_f32 v11, v76, v80
  ds_write_b64 v20, v[10:11] offset:0
  v_pk_mul_f32 v[84:85], v[84:85], v[24:25]
  v_pk_mul_f32 v[86:87], v[86:87], v[26:27]
  v_cvt_pk_bf16_f32 v68, v69, v73
  v_cvt_pk_bf16_f32 v69, v77, v81
  ds_write_b64 v18, v[68:69] offset:384
  v_pk_mul_f32 v[88:89], v[88:89], v[24:25]
  v_pk_mul_f32 v[90:91], v[90:91], v[26:27]
  v_cvt_pk_bf16_f32 v72, v70, v74
  v_cvt_pk_bf16_f32 v73, v78, v82
  ds_write_b64 v18, v[72:73] offset:768
  v_pk_mul_f32 v[92:93], v[92:93], v[24:25]
  v_pk_mul_f32 v[94:95], v[94:95], v[26:27]
  v_cvt_pk_bf16_f32 v70, v71, v75
  v_cvt_pk_bf16_f32 v71, v79, v83
  ds_write_b64 v20, v[70:71] offset:1152
  v_pk_mul_f32 v[96:97], v[96:97], v[24:25]
  v_pk_mul_f32 v[98:99], v[98:99], v[26:27]
  v_cvt_pk_bf16_f32 v10, v84, v88
  v_cvt_pk_bf16_f32 v11, v92, v96
  ds_write_b64 v20, v[10:11] offset:128
  v_pk_mul_f32 v[100:101], v[100:101], v[24:25]
  v_pk_mul_f32 v[102:103], v[102:103], v[26:27]
  v_cvt_pk_bf16_f32 v84, v85, v89
  v_cvt_pk_bf16_f32 v85, v93, v97
  ds_write_b64 v20, v[84:85] offset:512
  v_pk_mul_f32 v[104:105], v[104:105], v[24:25]
  v_pk_mul_f32 v[106:107], v[106:107], v[26:27]
  v_cvt_pk_bf16_f32 v88, v86, v90
  v_cvt_pk_bf16_f32 v89, v94, v98
  ds_write_b64 v18, v[88:89] offset:896
  v_pk_mul_f32 v[108:109], v[108:109], v[24:25]
  v_pk_mul_f32 v[110:111], v[110:111], v[26:27]
  v_cvt_pk_bf16_f32 v86, v87, v91
  v_cvt_pk_bf16_f32 v87, v95, v99
  ds_write_b64 v18, v[86:87] offset:1280
  v_pk_mul_f32 v[112:113], v[112:113], v[24:25]
  v_pk_mul_f32 v[114:115], v[114:115], v[26:27]
  v_cvt_pk_bf16_f32 v10, v100, v104
  v_cvt_pk_bf16_f32 v11, v108, v112
  ds_write_b64 v18, v[10:11] offset:256
  v_cvt_pk_bf16_f32 v100, v101, v105
  v_cvt_pk_bf16_f32 v101, v109, v113
  ds_write_b64 v20, v[100:101] offset:640
  v_cvt_pk_bf16_f32 v104, v102, v106
  v_cvt_pk_bf16_f32 v105, v110, v114
  ds_write_b64 v20, v[104:105] offset:1024
  v_cvt_pk_bf16_f32 v102, v103, v107
  v_cvt_pk_bf16_f32 v103, v111, v115
  ds_write_b64 v18, v[102:103] offset:1408
  ds_read_b64_tr_b16 v[68:69], v21 offset:0
  ds_read_b64_tr_b16 v[70:71], v19 offset:0
  ds_read_b64_tr_b16 v[72:73], v21 offset:1024
  ds_read_b64_tr_b16 v[74:75], v19 offset:1024
  ds_read_b64_tr_b16 v[76:77], v21 offset:2048
  ds_read_b64_tr_b16 v[78:79], v19 offset:2048
  ds_read_b64_tr_b16 v[80:81], v21 offset:3072
  ds_read_b64_tr_b16 v[82:83], v19 offset:3072
  ds_read_b64_tr_b16 v[84:85], v21 offset:4096
  ds_read_b64_tr_b16 v[86:87], v19 offset:4096
  ds_read_b64_tr_b16 v[88:89], v21 offset:5120
  ds_read_b64_tr_b16 v[90:91], v19 offset:5120
  v_pk_mul_f32 v[116:117], v[116:117], v[28:29]
  v_pk_mul_f32 v[118:119], v[118:119], v[30:31]
  v_pk_mul_f32 v[120:121], v[120:121], v[28:29]
  v_pk_mul_f32 v[122:123], v[122:123], v[30:31]
  v_pk_mul_f32 v[124:125], v[124:125], v[28:29]
  v_pk_mul_f32 v[126:127], v[126:127], v[30:31]
  v_pk_mul_f32 v[128:129], v[128:129], v[28:29]
  v_pk_mul_f32 v[130:131], v[130:131], v[30:31]
  v_cvt_pk_bf16_f32 v10, v116, v120
  v_cvt_pk_bf16_f32 v11, v124, v128
  ds_write_b64 v20, v[10:11] offset:6144
  v_pk_mul_f32 v[132:133], v[132:133], v[28:29]
  v_pk_mul_f32 v[134:135], v[134:135], v[30:31]
  v_cvt_pk_bf16_f32 v116, v117, v121
  v_cvt_pk_bf16_f32 v117, v125, v129
  ds_write_b64 v18, v[116:117] offset:6528
  v_pk_mul_f32 v[136:137], v[136:137], v[28:29]
  v_pk_mul_f32 v[138:139], v[138:139], v[30:31]
  v_cvt_pk_bf16_f32 v120, v118, v122
  v_cvt_pk_bf16_f32 v121, v126, v130
  ds_write_b64 v18, v[120:121] offset:6912
  v_pk_mul_f32 v[140:141], v[140:141], v[28:29]
  v_pk_mul_f32 v[142:143], v[142:143], v[30:31]
  v_cvt_pk_bf16_f32 v118, v119, v123
  v_cvt_pk_bf16_f32 v119, v127, v131
  ds_write_b64 v20, v[118:119] offset:7296
  s_mov_b32 s42, 0
  s_waitcnt lgkmcnt(14)
  buffer_store_dwordx4 v[68:71], v22, s[28:31], s42 offen offset:0 nt
  v_pk_mul_f32 v[144:145], v[144:145], v[28:29]
  v_pk_mul_f32 v[146:147], v[146:147], v[30:31]
  v_cvt_pk_bf16_f32 v10, v132, v136
  v_cvt_pk_bf16_f32 v11, v140, v144
  ds_write_b64 v20, v[10:11] offset:6272
  s_waitcnt lgkmcnt(13)
  buffer_store_dwordx4 v[72:75], v22, s[28:31], s42 offen offset:1024 nt
  v_pk_mul_f32 v[148:149], v[148:149], v[28:29]
  v_pk_mul_f32 v[150:151], v[150:151], v[30:31]
  v_cvt_pk_bf16_f32 v132, v133, v137
  v_cvt_pk_bf16_f32 v133, v141, v145
  ds_write_b64 v20, v[132:133] offset:6656
  s_waitcnt lgkmcnt(12)
  buffer_store_dwordx4 v[76:79], v22, s[28:31], s42 offen offset:2048 nt
  v_pk_mul_f32 v[152:153], v[152:153], v[28:29]
  v_pk_mul_f32 v[154:155], v[154:155], v[30:31]
  v_cvt_pk_bf16_f32 v136, v134, v138
  v_cvt_pk_bf16_f32 v137, v142, v146
  ds_write_b64 v18, v[136:137] offset:7040
  s_waitcnt lgkmcnt(11)
  buffer_store_dwordx4 v[80:83], v22, s[28:31], s42 offen offset:3072 nt
  v_pk_mul_f32 v[156:157], v[156:157], v[28:29]
  v_pk_mul_f32 v[158:159], v[158:159], v[30:31]
  v_cvt_pk_bf16_f32 v134, v135, v139
  v_cvt_pk_bf16_f32 v135, v143, v147
  ds_write_b64 v18, v[134:135] offset:7424
  s_mov_b32 s42, 4096
  s_waitcnt lgkmcnt(10)
  buffer_store_dwordx4 v[84:87], v22, s[28:31], s42 offen offset:0 nt
  v_pk_mul_f32 v[160:161], v[160:161], v[28:29]
  v_pk_mul_f32 v[162:163], v[162:163], v[30:31]
  v_cvt_pk_bf16_f32 v10, v148, v152
  v_cvt_pk_bf16_f32 v11, v156, v160
  ds_write_b64 v18, v[10:11] offset:6400
  s_waitcnt lgkmcnt(9)
  buffer_store_dwordx4 v[88:91], v22, s[28:31], s42 offen offset:1024 nt
  v_cvt_pk_bf16_f32 v148, v149, v153
  v_cvt_pk_bf16_f32 v149, v157, v161
  ds_write_b64 v20, v[148:149] offset:6784
  v_cvt_pk_bf16_f32 v152, v150, v154
  v_cvt_pk_bf16_f32 v153, v158, v162
  ds_write_b64 v20, v[152:153] offset:7168
  v_cvt_pk_bf16_f32 v150, v151, v155
  v_cvt_pk_bf16_f32 v151, v159, v163
  ds_write_b64 v18, v[150:151] offset:7552
  ds_read_b64_tr_b16 v[116:117], v21 offset:6144
  ds_read_b64_tr_b16 v[118:119], v19 offset:6144
  ds_read_b64_tr_b16 v[120:121], v21 offset:7168
  ds_read_b64_tr_b16 v[122:123], v19 offset:7168
  ds_read_b64_tr_b16 v[124:125], v21 offset:8192
  ds_read_b64_tr_b16 v[126:127], v19 offset:8192
  ds_read_b64_tr_b16 v[128:129], v21 offset:9216
  ds_read_b64_tr_b16 v[130:131], v19 offset:9216
  ds_read_b64_tr_b16 v[132:133], v21 offset:10240
  ds_read_b64_tr_b16 v[134:135], v19 offset:10240
  ds_read_b64_tr_b16 v[136:137], v21 offset:11264
  ds_read_b64_tr_b16 v[138:139], v19 offset:11264
  v_pk_mul_f32 v[164:165], v[164:165], v[32:33]
  v_pk_mul_f32 v[166:167], v[166:167], v[34:35]
  v_pk_mul_f32 v[168:169], v[168:169], v[32:33]
  v_pk_mul_f32 v[170:171], v[170:171], v[34:35]
  v_pk_mul_f32 v[172:173], v[172:173], v[32:33]
  v_pk_mul_f32 v[174:175], v[174:175], v[34:35]
  v_pk_mul_f32 v[176:177], v[176:177], v[32:33]
  v_pk_mul_f32 v[178:179], v[178:179], v[34:35]
  v_cvt_pk_bf16_f32 v10, v164, v168
  v_cvt_pk_bf16_f32 v11, v172, v176
  ds_write_b64 v20, v[10:11] offset:0
  v_pk_mul_f32 v[180:181], v[180:181], v[32:33]
  v_pk_mul_f32 v[182:183], v[182:183], v[34:35]
  v_cvt_pk_bf16_f32 v164, v165, v169
  v_cvt_pk_bf16_f32 v165, v173, v177
  ds_write_b64 v18, v[164:165] offset:384
  v_pk_mul_f32 v[184:185], v[184:185], v[32:33]
  v_pk_mul_f32 v[186:187], v[186:187], v[34:35]
  v_cvt_pk_bf16_f32 v168, v166, v170
  v_cvt_pk_bf16_f32 v169, v174, v178
  ds_write_b64 v18, v[168:169] offset:768
  v_pk_mul_f32 v[188:189], v[188:189], v[32:33]
  v_pk_mul_f32 v[190:191], v[190:191], v[34:35]
  v_cvt_pk_bf16_f32 v166, v167, v171
  v_cvt_pk_bf16_f32 v167, v175, v179
  ds_write_b64 v20, v[166:167] offset:1152
  s_mov_b32 s42, 6144
  s_waitcnt lgkmcnt(14)
  buffer_store_dwordx4 v[116:119], v22, s[28:31], s42 offen offset:0 nt
  v_pk_mul_f32 v[192:193], v[192:193], v[32:33]
  v_pk_mul_f32 v[194:195], v[194:195], v[34:35]
  v_cvt_pk_bf16_f32 v10, v180, v184
  v_cvt_pk_bf16_f32 v11, v188, v192
  ds_write_b64 v20, v[10:11] offset:128
  s_waitcnt lgkmcnt(13)
  buffer_store_dwordx4 v[120:123], v22, s[28:31], s42 offen offset:1024 nt
  v_pk_mul_f32 v[196:197], v[196:197], v[32:33]
  v_pk_mul_f32 v[198:199], v[198:199], v[34:35]
  v_cvt_pk_bf16_f32 v180, v181, v185
  v_cvt_pk_bf16_f32 v181, v189, v193
  ds_write_b64 v20, v[180:181] offset:512
  s_waitcnt lgkmcnt(12)
  buffer_store_dwordx4 v[124:127], v22, s[28:31], s42 offen offset:2048 nt
  v_pk_mul_f32 v[200:201], v[200:201], v[32:33]
  v_pk_mul_f32 v[202:203], v[202:203], v[34:35]
  v_cvt_pk_bf16_f32 v184, v182, v186
  v_cvt_pk_bf16_f32 v185, v190, v194
  ds_write_b64 v18, v[184:185] offset:896
  s_waitcnt lgkmcnt(11)
  buffer_store_dwordx4 v[128:131], v22, s[28:31], s42 offen offset:3072 nt
  v_pk_mul_f32 v[204:205], v[204:205], v[32:33]
  v_pk_mul_f32 v[206:207], v[206:207], v[34:35]
  v_cvt_pk_bf16_f32 v182, v183, v187
  v_cvt_pk_bf16_f32 v183, v191, v195
  ds_write_b64 v18, v[182:183] offset:1280
  s_mov_b32 s42, 10240
  s_waitcnt lgkmcnt(10)
  buffer_store_dwordx4 v[132:135], v22, s[28:31], s42 offen offset:0 nt
  v_pk_mul_f32 v[208:209], v[208:209], v[32:33]
  v_pk_mul_f32 v[210:211], v[210:211], v[34:35]
  v_cvt_pk_bf16_f32 v10, v196, v200
  v_cvt_pk_bf16_f32 v11, v204, v208
  ds_write_b64 v18, v[10:11] offset:256
  s_waitcnt lgkmcnt(9)
  buffer_store_dwordx4 v[136:139], v22, s[28:31], s42 offen offset:1024 nt
  v_cvt_pk_bf16_f32 v196, v197, v201
  v_cvt_pk_bf16_f32 v197, v205, v209
  ds_write_b64 v20, v[196:197] offset:640
  v_cvt_pk_bf16_f32 v200, v198, v202
  v_cvt_pk_bf16_f32 v201, v206, v210
  ds_write_b64 v20, v[200:201] offset:1024
  v_cvt_pk_bf16_f32 v198, v199, v203
  v_cvt_pk_bf16_f32 v199, v207, v211
  ds_write_b64 v18, v[198:199] offset:1408
  ds_read_b64_tr_b16 v[164:165], v21 offset:0
  ds_read_b64_tr_b16 v[166:167], v19 offset:0
  ds_read_b64_tr_b16 v[168:169], v21 offset:1024
  ds_read_b64_tr_b16 v[170:171], v19 offset:1024
  ds_read_b64_tr_b16 v[172:173], v21 offset:2048
  ds_read_b64_tr_b16 v[174:175], v19 offset:2048
  ds_read_b64_tr_b16 v[176:177], v21 offset:3072
  ds_read_b64_tr_b16 v[178:179], v19 offset:3072
  ds_read_b64_tr_b16 v[180:181], v21 offset:4096
  ds_read_b64_tr_b16 v[182:183], v19 offset:4096
  ds_read_b64_tr_b16 v[184:185], v21 offset:5120
  ds_read_b64_tr_b16 v[186:187], v19 offset:5120
  v_pk_mul_f32 v[212:213], v[212:213], v[12:13]
  v_pk_mul_f32 v[214:215], v[214:215], v[14:15]
  v_pk_mul_f32 v[216:217], v[216:217], v[12:13]
  v_pk_mul_f32 v[218:219], v[218:219], v[14:15]
  v_pk_mul_f32 v[220:221], v[220:221], v[12:13]
  v_pk_mul_f32 v[222:223], v[222:223], v[14:15]
  v_pk_mul_f32 v[224:225], v[224:225], v[12:13]
  v_pk_mul_f32 v[226:227], v[226:227], v[14:15]
  v_cvt_pk_bf16_f32 v10, v212, v216
  v_cvt_pk_bf16_f32 v11, v220, v224
  ds_write_b64 v20, v[10:11] offset:6144
  v_pk_mul_f32 v[228:229], v[228:229], v[12:13]
  v_pk_mul_f32 v[230:231], v[230:231], v[14:15]
  v_cvt_pk_bf16_f32 v212, v213, v217
  v_cvt_pk_bf16_f32 v213, v221, v225
  ds_write_b64 v18, v[212:213] offset:6528
  v_pk_mul_f32 v[232:233], v[232:233], v[12:13]
  v_pk_mul_f32 v[234:235], v[234:235], v[14:15]
  v_cvt_pk_bf16_f32 v216, v214, v218
  v_cvt_pk_bf16_f32 v217, v222, v226
  ds_write_b64 v18, v[216:217] offset:6912
  v_pk_mul_f32 v[236:237], v[236:237], v[12:13]
  v_pk_mul_f32 v[238:239], v[238:239], v[14:15]
  v_cvt_pk_bf16_f32 v214, v215, v219
  v_cvt_pk_bf16_f32 v215, v223, v227
  ds_write_b64 v20, v[214:215] offset:7296
  s_mov_b32 s42, 12288
  s_waitcnt lgkmcnt(14)
  buffer_store_dwordx4 v[164:167], v22, s[28:31], s42 offen offset:0 nt
  v_pk_mul_f32 v[240:241], v[240:241], v[12:13]
  v_pk_mul_f32 v[242:243], v[242:243], v[14:15]
  v_cvt_pk_bf16_f32 v10, v228, v232
  v_cvt_pk_bf16_f32 v11, v236, v240
  ds_write_b64 v20, v[10:11] offset:6272
  s_waitcnt lgkmcnt(13)
  buffer_store_dwordx4 v[168:171], v22, s[28:31], s42 offen offset:1024 nt
  v_pk_mul_f32 v[244:245], v[244:245], v[12:13]
  v_pk_mul_f32 v[246:247], v[246:247], v[14:15]
  v_cvt_pk_bf16_f32 v228, v229, v233
  v_cvt_pk_bf16_f32 v229, v237, v241
  ds_write_b64 v20, v[228:229] offset:6656
  s_waitcnt lgkmcnt(12)
  buffer_store_dwordx4 v[172:175], v22, s[28:31], s42 offen offset:2048 nt
  v_pk_mul_f32 v[248:249], v[248:249], v[12:13]
  v_pk_mul_f32 v[250:251], v[250:251], v[14:15]
  v_cvt_pk_bf16_f32 v232, v230, v234
  v_cvt_pk_bf16_f32 v233, v238, v242
  ds_write_b64 v18, v[232:233] offset:7040
  s_waitcnt lgkmcnt(11)
  buffer_store_dwordx4 v[176:179], v22, s[28:31], s42 offen offset:3072 nt
  v_pk_mul_f32 v[252:253], v[252:253], v[12:13]
  v_pk_mul_f32 v[254:255], v[254:255], v[14:15]
  v_cvt_pk_bf16_f32 v230, v231, v235
  v_cvt_pk_bf16_f32 v231, v239, v243
  ds_write_b64 v18, v[230:231] offset:7424
  s_mov_b32 s42, 16384
  s_waitcnt lgkmcnt(10)
  buffer_store_dwordx4 v[180:183], v22, s[28:31], s42 offen offset:0 nt
  v_accvgpr_read_b32 v104, a156
  v_accvgpr_read_b32 v105, a157
  v_accvgpr_read_b32 v106, a158
  v_accvgpr_read_b32 v107, a159
  v_pk_mul_f32 v[104:105], v[104:105], v[12:13]
  v_pk_mul_f32 v[106:107], v[106:107], v[14:15]
  v_cvt_pk_bf16_f32 v10, v244, v248
  v_cvt_pk_bf16_f32 v11, v252, v104
  ds_write_b64 v18, v[10:11] offset:6400
  s_waitcnt lgkmcnt(9)
  buffer_store_dwordx4 v[184:187], v22, s[28:31], s42 offen offset:1024 nt
  v_cvt_pk_bf16_f32 v244, v245, v249
  v_cvt_pk_bf16_f32 v245, v253, v105
  ds_write_b64 v20, v[244:245] offset:6784
  v_cvt_pk_bf16_f32 v248, v246, v250
  v_cvt_pk_bf16_f32 v249, v254, v106
  ds_write_b64 v20, v[248:249] offset:7168
  v_cvt_pk_bf16_f32 v246, v247, v251
  v_cvt_pk_bf16_f32 v247, v255, v107
  ds_write_b64 v18, v[246:247] offset:7552
  ds_read_b64_tr_b16 v[212:213], v21 offset:6144
  ds_read_b64_tr_b16 v[214:215], v19 offset:6144
  ds_read_b64_tr_b16 v[216:217], v21 offset:7168
  ds_read_b64_tr_b16 v[218:219], v19 offset:7168
  ds_read_b64_tr_b16 v[220:221], v21 offset:8192
  ds_read_b64_tr_b16 v[222:223], v19 offset:8192
  ds_read_b64_tr_b16 v[224:225], v21 offset:9216
  ds_read_b64_tr_b16 v[226:227], v19 offset:9216
  ds_read_b64_tr_b16 v[228:229], v21 offset:10240
  ds_read_b64_tr_b16 v[230:231], v19 offset:10240
  ds_read_b64_tr_b16 v[232:233], v21 offset:11264
  ds_read_b64_tr_b16 v[234:235], v19 offset:11264
  s_mov_b32 s42, 18432
  s_waitcnt lgkmcnt(10)
  buffer_store_dwordx4 v[212:215], v22, s[28:31], s42 offen offset:0 nt
  s_waitcnt lgkmcnt(8)
  buffer_store_dwordx4 v[216:219], v22, s[28:31], s42 offen offset:1024 nt
  s_waitcnt lgkmcnt(6)
  buffer_store_dwordx4 v[220:223], v22, s[28:31], s42 offen offset:2048 nt
  s_waitcnt lgkmcnt(4)
  buffer_store_dwordx4 v[224:227], v22, s[28:31], s42 offen offset:3072 nt
  s_mov_b32 s42, 22528
  s_waitcnt lgkmcnt(2)
  buffer_store_dwordx4 v[228:231], v22, s[28:31], s42 offen offset:0 nt
  s_waitcnt lgkmcnt(0)
  buffer_store_dwordx4 v[232:235], v22, s[28:31], s42 offen offset:1024 nt
  v_mov_b32 v16, 1.0
  s_nop 1
  v_mfma_f32_16x16x4_f32 v[24:27], v8, v16, 0
  v_mfma_f32_16x16x4_f32 v[28:31], v9, v16, 0
  s_nop 10
  v_rcp_f32 v24, v24
  v_rcp_f32 v25, v25
  v_rcp_f32 v26, v26
  v_rcp_f32 v27, v27
  v_rcp_f32 v28, v28
  v_rcp_f32 v29, v29
  v_rcp_f32 v30, v30
  v_rcp_f32 v31, v31
  v_xor_b32 v18, 64, v20
  v_xor_b32 v19, 64, v21
  v_accvgpr_read_b32 v92, a160
  v_accvgpr_read_b32 v93, a161
  v_accvgpr_read_b32 v94, a162
  v_accvgpr_read_b32 v95, a163
  v_pk_mul_f32 v[92:93], v[92:93], v[24:25]
  v_pk_mul_f32 v[94:95], v[94:95], v[26:27]
  v_accvgpr_read_b32 v96, a164
  v_accvgpr_read_b32 v97, a165
  v_accvgpr_read_b32 v98, a166
  v_accvgpr_read_b32 v99, a167
  v_pk_mul_f32 v[96:97], v[96:97], v[24:25]
  v_pk_mul_f32 v[98:99], v[98:99], v[26:27]
  v_accvgpr_read_b32 v100, a168
  v_accvgpr_read_b32 v101, a169
  v_accvgpr_read_b32 v102, a170
  v_accvgpr_read_b32 v103, a171
  v_pk_mul_f32 v[100:101], v[100:101], v[24:25]
  v_pk_mul_f32 v[102:103], v[102:103], v[26:27]
  v_accvgpr_read_b32 v104, a172
  v_accvgpr_read_b32 v105, a173
  v_accvgpr_read_b32 v106, a174
  v_accvgpr_read_b32 v107, a175
  v_pk_mul_f32 v[104:105], v[104:105], v[24:25]
  v_pk_mul_f32 v[106:107], v[106:107], v[26:27]
  v_cvt_pk_bf16_f32 v10, v92, v96
  v_cvt_pk_bf16_f32 v11, v100, v104
  ds_write_b64 v20, v[10:11] offset:0
  v_accvgpr_read_b32 v108, a176
  v_accvgpr_read_b32 v109, a177
  v_accvgpr_read_b32 v110, a178
  v_accvgpr_read_b32 v111, a179
  v_pk_mul_f32 v[108:109], v[108:109], v[24:25]
  v_pk_mul_f32 v[110:111], v[110:111], v[26:27]
  v_cvt_pk_bf16_f32 v92, v93, v97
  v_cvt_pk_bf16_f32 v93, v101, v105
  ds_write_b64 v18, v[92:93] offset:384
  v_accvgpr_read_b32 v112, a180
  v_accvgpr_read_b32 v113, a181
  v_accvgpr_read_b32 v114, a182
  v_accvgpr_read_b32 v115, a183
  v_pk_mul_f32 v[112:113], v[112:113], v[24:25]
  v_pk_mul_f32 v[114:115], v[114:115], v[26:27]
  v_cvt_pk_bf16_f32 v96, v94, v98
  v_cvt_pk_bf16_f32 v97, v102, v106
  ds_write_b64 v18, v[96:97] offset:768
  v_accvgpr_read_b32 v140, a184
  v_accvgpr_read_b32 v141, a185
  v_accvgpr_read_b32 v142, a186
  v_accvgpr_read_b32 v143, a187
  v_pk_mul_f32 v[140:141], v[140:141], v[24:25]
  v_pk_mul_f32 v[142:143], v[142:143], v[26:27]
  v_cvt_pk_bf16_f32 v94, v95, v99
  v_cvt_pk_bf16_f32 v95, v103, v107
  ds_write_b64 v20, v[94:95] offset:1152
  v_accvgpr_read_b32 v144, a188
  v_accvgpr_read_b32 v145, a189
  v_accvgpr_read_b32 v146, a190
  v_accvgpr_read_b32 v147, a191
  v_pk_mul_f32 v[144:145], v[144:145], v[24:25]
  v_pk_mul_f32 v[146:147], v[146:147], v[26:27]
  v_cvt_pk_bf16_f32 v10, v108, v112
  v_cvt_pk_bf16_f32 v11, v140, v144
  ds_write_b64 v20, v[10:11] offset:128
  v_accvgpr_read_b32 v92, a192
  v_accvgpr_read_b32 v93, a193
  v_accvgpr_read_b32 v94, a194
  v_accvgpr_read_b32 v95, a195
  v_pk_mul_f32 v[92:93], v[92:93], v[24:25]
  v_pk_mul_f32 v[94:95], v[94:95], v[26:27]
  v_cvt_pk_bf16_f32 v108, v109, v113
  v_cvt_pk_bf16_f32 v109, v141, v145
  ds_write_b64 v20, v[108:109] offset:512
  v_accvgpr_read_b32 v96, a196
  v_accvgpr_read_b32 v97, a197
  v_accvgpr_read_b32 v98, a198
  v_accvgpr_read_b32 v99, a199
  v_pk_mul_f32 v[96:97], v[96:97], v[24:25]
  v_pk_mul_f32 v[98:99], v[98:99], v[26:27]
  v_cvt_pk_bf16_f32 v112, v110, v114
  v_cvt_pk_bf16_f32 v113, v142, v146
  ds_write_b64 v18, v[112:113] offset:896
  v_accvgpr_read_b32 v100, a200
  v_accvgpr_read_b32 v101, a201
  v_accvgpr_read_b32 v102, a202
  v_accvgpr_read_b32 v103, a203
  v_pk_mul_f32 v[100:101], v[100:101], v[24:25]
  v_pk_mul_f32 v[102:103], v[102:103], v[26:27]
  v_cvt_pk_bf16_f32 v110, v111, v115
  v_cvt_pk_bf16_f32 v111, v143, v147
  ds_write_b64 v18, v[110:111] offset:1280
  v_accvgpr_read_b32 v104, a204
  v_accvgpr_read_b32 v105, a205
  v_accvgpr_read_b32 v106, a206
  v_accvgpr_read_b32 v107, a207
  v_pk_mul_f32 v[104:105], v[104:105], v[24:25]
  v_pk_mul_f32 v[106:107], v[106:107], v[26:27]
  v_cvt_pk_bf16_f32 v10, v92, v96
  v_cvt_pk_bf16_f32 v11, v100, v104
  ds_write_b64 v18, v[10:11] offset:256
  v_cvt_pk_bf16_f32 v92, v93, v97
  v_cvt_pk_bf16_f32 v93, v101, v105
  ds_write_b64 v20, v[92:93] offset:640
  v_cvt_pk_bf16_f32 v96, v94, v98
  v_cvt_pk_bf16_f32 v97, v102, v106
  ds_write_b64 v20, v[96:97] offset:1024
  v_cvt_pk_bf16_f32 v94, v95, v99
  v_cvt_pk_bf16_f32 v95, v103, v107
  ds_write_b64 v18, v[94:95] offset:1408
  ds_read_b64_tr_b16 a[160:161], v21 offset:0
  ds_read_b64_tr_b16 a[162:163], v19 offset:0
  ds_read_b64_tr_b16 a[164:165], v21 offset:1024
  ds_read_b64_tr_b16 a[166:167], v19 offset:1024
  ds_read_b64_tr_b16 a[168:169], v21 offset:2048
  ds_read_b64_tr_b16 a[170:171], v19 offset:2048
  ds_read_b64_tr_b16 a[172:173], v21 offset:3072
  ds_read_b64_tr_b16 a[174:175], v19 offset:3072
  ds_read_b64_tr_b16 a[176:177], v21 offset:4096
  ds_read_b64_tr_b16 a[178:179], v19 offset:4096
  ds_read_b64_tr_b16 a[180:181], v21 offset:5120
  ds_read_b64_tr_b16 a[182:183], v19 offset:5120
  v_accvgpr_read_b32 v92, a208
  v_accvgpr_read_b32 v93, a209
  v_accvgpr_read_b32 v94, a210
  v_accvgpr_read_b32 v95, a211
  v_pk_mul_f32 v[92:93], v[92:93], v[28:29]
  v_pk_mul_f32 v[94:95], v[94:95], v[30:31]
  v_accvgpr_read_b32 v96, a212
  v_accvgpr_read_b32 v97, a213
  v_accvgpr_read_b32 v98, a214
  v_accvgpr_read_b32 v99, a215
  v_pk_mul_f32 v[96:97], v[96:97], v[28:29]
  v_pk_mul_f32 v[98:99], v[98:99], v[30:31]
  v_accvgpr_read_b32 v100, a216
  v_accvgpr_read_b32 v101, a217
  v_accvgpr_read_b32 v102, a218
  v_accvgpr_read_b32 v103, a219
  v_pk_mul_f32 v[100:101], v[100:101], v[28:29]
  v_pk_mul_f32 v[102:103], v[102:103], v[30:31]
  v_accvgpr_read_b32 v104, a220
  v_accvgpr_read_b32 v105, a221
  v_accvgpr_read_b32 v106, a222
  v_accvgpr_read_b32 v107, a223
  v_pk_mul_f32 v[104:105], v[104:105], v[28:29]
  v_pk_mul_f32 v[106:107], v[106:107], v[30:31]
  v_cvt_pk_bf16_f32 v10, v92, v96
  v_cvt_pk_bf16_f32 v11, v100, v104
  ds_write_b64 v20, v[10:11] offset:6144
  v_accvgpr_read_b32 v108, a224
  v_accvgpr_read_b32 v109, a225
  v_accvgpr_read_b32 v110, a226
  v_accvgpr_read_b32 v111, a227
  v_pk_mul_f32 v[108:109], v[108:109], v[28:29]
  v_pk_mul_f32 v[110:111], v[110:111], v[30:31]
  v_cvt_pk_bf16_f32 v92, v93, v97
  v_cvt_pk_bf16_f32 v93, v101, v105
  ds_write_b64 v18, v[92:93] offset:6528
  v_accvgpr_read_b32 v112, a228
  v_accvgpr_read_b32 v113, a229
  v_accvgpr_read_b32 v114, a230
  v_accvgpr_read_b32 v115, a231
  v_pk_mul_f32 v[112:113], v[112:113], v[28:29]
  v_pk_mul_f32 v[114:115], v[114:115], v[30:31]
  v_cvt_pk_bf16_f32 v96, v94, v98
  v_cvt_pk_bf16_f32 v97, v102, v106
  ds_write_b64 v18, v[96:97] offset:6912
  v_accvgpr_read_b32 v140, a232
  v_accvgpr_read_b32 v141, a233
  v_accvgpr_read_b32 v142, a234
  v_accvgpr_read_b32 v143, a235
  v_pk_mul_f32 v[140:141], v[140:141], v[28:29]
  v_pk_mul_f32 v[142:143], v[142:143], v[30:31]
  v_cvt_pk_bf16_f32 v94, v95, v99
  v_cvt_pk_bf16_f32 v95, v103, v107
  ds_write_b64 v20, v[94:95] offset:7296
  s_mov_b32 s42, 24576
  s_waitcnt lgkmcnt(14)
  buffer_store_dwordx4 a[160:163], v22, s[28:31], s42 offen offset:0 nt
  v_accvgpr_read_b32 v144, a236
  v_accvgpr_read_b32 v145, a237
  v_accvgpr_read_b32 v146, a238
  v_accvgpr_read_b32 v147, a239
  v_pk_mul_f32 v[144:145], v[144:145], v[28:29]
  v_pk_mul_f32 v[146:147], v[146:147], v[30:31]
  v_cvt_pk_bf16_f32 v10, v108, v112
  v_cvt_pk_bf16_f32 v11, v140, v144
  ds_write_b64 v20, v[10:11] offset:6272
  s_waitcnt lgkmcnt(13)
  buffer_store_dwordx4 a[164:167], v22, s[28:31], s42 offen offset:1024 nt
  v_accvgpr_read_b32 v92, a240
  v_accvgpr_read_b32 v93, a241
  v_accvgpr_read_b32 v94, a242
  v_accvgpr_read_b32 v95, a243
  v_pk_mul_f32 v[92:93], v[92:93], v[28:29]
  v_pk_mul_f32 v[94:95], v[94:95], v[30:31]
  v_cvt_pk_bf16_f32 v108, v109, v113
  v_cvt_pk_bf16_f32 v109, v141, v145
  ds_write_b64 v20, v[108:109] offset:6656
  s_waitcnt lgkmcnt(12)
  buffer_store_dwordx4 a[168:171], v22, s[28:31], s42 offen offset:2048 nt
  v_accvgpr_read_b32 v96, a244
  v_accvgpr_read_b32 v97, a245
  v_accvgpr_read_b32 v98, a246
  v_accvgpr_read_b32 v99, a247
  v_pk_mul_f32 v[96:97], v[96:97], v[28:29]
  v_pk_mul_f32 v[98:99], v[98:99], v[30:31]
  v_cvt_pk_bf16_f32 v112, v110, v114
  v_cvt_pk_bf16_f32 v113, v142, v146
  ds_write_b64 v18, v[112:113] offset:7040
  s_waitcnt lgkmcnt(11)
  buffer_store_dwordx4 a[172:175], v22, s[28:31], s42 offen offset:3072 nt
  v_accvgpr_read_b32 v100, a248
  v_accvgpr_read_b32 v101, a249
  v_accvgpr_read_b32 v102, a250
  v_accvgpr_read_b32 v103, a251
  v_pk_mul_f32 v[100:101], v[100:101], v[28:29]
  v_pk_mul_f32 v[102:103], v[102:103], v[30:31]
  v_cvt_pk_bf16_f32 v110, v111, v115
  v_cvt_pk_bf16_f32 v111, v143, v147
  ds_write_b64 v18, v[110:111] offset:7424
  s_mov_b32 s42, 28672
  s_waitcnt lgkmcnt(10)
  buffer_store_dwordx4 a[176:179], v22, s[28:31], s42 offen offset:0 nt
  v_accvgpr_read_b32 v104, a252
  v_accvgpr_read_b32 v105, a253
  v_accvgpr_read_b32 v106, a254
  v_accvgpr_read_b32 v107, a255
  v_pk_mul_f32 v[104:105], v[104:105], v[28:29]
  v_pk_mul_f32 v[106:107], v[106:107], v[30:31]
  v_cvt_pk_bf16_f32 v10, v92, v96
  v_cvt_pk_bf16_f32 v11, v100, v104
  ds_write_b64 v18, v[10:11] offset:6400
  s_waitcnt lgkmcnt(9)
  buffer_store_dwordx4 a[180:183], v22, s[28:31], s42 offen offset:1024 nt
  v_cvt_pk_bf16_f32 v92, v93, v97
  v_cvt_pk_bf16_f32 v93, v101, v105
  ds_write_b64 v20, v[92:93] offset:6784
  v_cvt_pk_bf16_f32 v96, v94, v98
  v_cvt_pk_bf16_f32 v97, v102, v106
  ds_write_b64 v20, v[96:97] offset:7168
  v_cvt_pk_bf16_f32 v94, v95, v99
  v_cvt_pk_bf16_f32 v95, v103, v107
  ds_write_b64 v18, v[94:95] offset:7552
  ds_read_b64_tr_b16 a[208:209], v21 offset:6144
  ds_read_b64_tr_b16 a[210:211], v19 offset:6144
  ds_read_b64_tr_b16 a[212:213], v21 offset:7168
  ds_read_b64_tr_b16 a[214:215], v19 offset:7168
  ds_read_b64_tr_b16 a[216:217], v21 offset:8192
  ds_read_b64_tr_b16 a[218:219], v19 offset:8192
  ds_read_b64_tr_b16 a[220:221], v21 offset:9216
  ds_read_b64_tr_b16 a[222:223], v19 offset:9216
  ds_read_b64_tr_b16 a[224:225], v21 offset:10240
  ds_read_b64_tr_b16 a[226:227], v19 offset:10240
  ds_read_b64_tr_b16 a[228:229], v21 offset:11264
  ds_read_b64_tr_b16 a[230:231], v19 offset:11264
  s_mov_b32 s42, 30720
  s_waitcnt lgkmcnt(10)
  buffer_store_dwordx4 a[208:211], v22, s[28:31], s42 offen offset:0 nt
  s_waitcnt lgkmcnt(8)
  buffer_store_dwordx4 a[212:215], v22, s[28:31], s42 offen offset:1024 nt
  s_waitcnt lgkmcnt(6)
  buffer_store_dwordx4 a[216:219], v22, s[28:31], s42 offen offset:2048 nt
  s_waitcnt lgkmcnt(4)
  buffer_store_dwordx4 a[220:223], v22, s[28:31], s42 offen offset:3072 nt
  s_mov_b32 s42, 34816
  s_waitcnt lgkmcnt(2)
  buffer_store_dwordx4 a[224:227], v22, s[28:31], s42 offen offset:0 nt
  s_waitcnt lgkmcnt(0)
  buffer_store_dwordx4 a[228:231], v22, s[28:31], s42 offen offset:1024 nt
  s_endpgm

.section .rodata,"a"
.p2align 6
.amdhsa_kernel standalone__gqa_softmax__near_ridge_kernel
  .amdhsa_next_free_vgpr 512
  .amdhsa_next_free_sgpr 102
  .amdhsa_accum_offset 256
  .amdhsa_group_segment_fixed_size 0
  .amdhsa_kernarg_size 48
  .amdhsa_user_sgpr_count 2
  .amdhsa_user_sgpr_kernarg_segment_ptr 1
  .amdhsa_system_sgpr_workgroup_id_x 1
.end_amdhsa_kernel
```
